```python
import torch

def _softmax(x, axis=-1):
    return torch.softmax(x, dim=axis)
def _gelu(x):
    return torch.nn.functional.gelu(x, approximate="tanh")
def _silu(x):
    return torch.nn.functional.silu(x)
def _sigmoid(x):
    return torch.sigmoid(x)
def _layernorm(x, axis=-1, eps=1e-5):
    m = x.mean(dim=axis, keepdim=True)
    v = x.var(dim=axis, keepdim=True, unbiased=False)
    return (x - m) / torch.sqrt(v + eps)
def _scatter_add(tgt, idx, src, axis=0):
    return tgt.clone().index_add_(axis, idx, src)
def _segment_sum(src, seg, n):
    out = torch.zeros((n,) + src.shape[1:], dtype=src.dtype)
    return out.index_add_(0, seg, src)
def _pad(x, pw):
    flat = tuple(v for pair in reversed(pw) for v in pair)
    return torch.nn.functional.pad(x, flat)

kernel_name = 'concat_heads__mha_block_cached__mha_block_cached__decode'

def setup_inputs():

    _w = (lambda a: (lambda t: t.to(torch.bfloat16) if t.is_floating_point() else t)(torch.as_tensor(a)))
    def _A_setup():
        B, Sq, D = 2, 1, 512
        H, Sk, Dh = 32, 8192, 128
        return {
            "x": _w((lambda *s: torch.randn(*s, dtype=torch.bfloat16) * 0.8)(B, Sq, D)),
            "k_cache": _w((lambda *s: torch.randn(*s, dtype=torch.bfloat16) * 0.8)(B, H, Sk, Dh)),
            "v_cache": _w((lambda *s: torch.randn(*s, dtype=torch.bfloat16) * 0.05)(B, H, Sk, Dh)),
            "wq": _w((lambda *s: torch.randn(*s, dtype=torch.bfloat16) * 0.8)(D, H * Dh) * (D ** -0.5)),
            "wo": _w((lambda *s: torch.randn(*s, dtype=torch.bfloat16) * 0.05)(H * Dh, D) * ((H * Dh) ** -0.5)),
        }
    _A_in = _A_setup()

    def _B_setup():
        B, Sq, D = 2, 1, 512
        H, Sk, Dh = 32, 8192, 128
        return {
            "x": _w((lambda *s: torch.randn(*s, dtype=torch.bfloat16) * 0.8)(B, Sq, D)),
            "k_cache": _w((lambda *s: torch.randn(*s, dtype=torch.bfloat16) * 0.8)(B, H, Sk, Dh)),
            "v_cache": _w((lambda *s: torch.randn(*s, dtype=torch.bfloat16) * 0.05)(B, H, Sk, Dh)),
            "wq": _w((lambda *s: torch.randn(*s, dtype=torch.bfloat16) * 0.8)(D, H * Dh) * (D ** -0.5)),
            "wo": _w((lambda *s: torch.randn(*s, dtype=torch.bfloat16) * 0.05)(H * Dh, D) * ((H * Dh) ** -0.5)),
        }
    _B_in = _B_setup()

    return {
        "A_x": _A_in["x"],
        "A_k_cache": _A_in["k_cache"],
        "A_v_cache": _A_in["v_cache"],
        "A_wq": _A_in["wq"],
        "A_wo": _A_in["wo"],
        "B_x": _B_in["x"],
        "B_k_cache": _B_in["k_cache"],
        "B_v_cache": _B_in["v_cache"],
        "B_wq": _B_in["wq"],
        "B_wo": _B_in["wo"],
    }

def reference(A_x, A_k_cache, A_v_cache, A_wq, A_wo, B_x, B_k_cache, B_v_cache, B_wq, B_wo):
    def _A_ref(x, k_cache, v_cache, wq, wo):
        B, Sq, D = x.shape
        H, Dh = 32, 128
        q = (lambda x, *d: x.permute(*d))((x @ wq).reshape(B, Sq, H, Dh), 0, 2, 1, 3)
        scores = torch.einsum("bhqd,bhkd->bhqk", q, k_cache) * (Dh ** -0.5)
        p = _softmax(scores, axis=-1)
        o = torch.einsum("bhqk,bhkd->bhqd", p, v_cache)
        return (lambda x, *d: x.permute(*d))(o, 0, 2, 1, 3).reshape(B, Sq, H * Dh) @ wo

    def _B_ref(x, k_cache, v_cache, wq, wo):
        B, Sq, D = x.shape
        H, Dh = 32, 128
        q = (lambda x, *d: x.permute(*d))((x @ wq).reshape(B, Sq, H, Dh), 0, 2, 1, 3)
        scores = torch.einsum("bhqd,bhkd->bhqk", q, k_cache) * (Dh ** -0.5)
        p = _softmax(scores, axis=-1)
        o = torch.einsum("bhqk,bhkd->bhqd", p, v_cache)
        return (lambda x, *d: x.permute(*d))(o, 0, 2, 1, 3).reshape(B, Sq, H * Dh) @ wo

    a = _A_ref(A_x, A_k_cache, A_v_cache, A_wq, A_wo)
    b = _B_ref(B_x, B_k_cache, B_v_cache, B_wq, B_wo)
    return torch.concatenate([a, b], axis=-1)
```

```asm
; @launch kernel=concat_heads__mha_block_cached__mha_block_cached__decode_kernel grid=(256,1,1) block=(512,1,1) lds=35456
; @launch kernel=mha_final_kernel grid=(128,1,1) block=(64,1,1) lds=0
.amdgcn_target "amdgcn-amd-amdhsa--gfx950"
.text
.globl concat_heads__mha_block_cached__mha_block_cached__decode_kernel
.p2align 8
.type concat_heads__mha_block_cached__mha_block_cached__decode_kernel,@function
concat_heads__mha_block_cached__mha_block_cached__decode_kernel:
s_load_dwordx16 s[4:19], s[0:1], 0
s_load_dwordx8 s[20:27], s[0:1], 64
s_load_dwordx2 s[28:29], s[0:1], 96
s_cmp_ge_u32 s2, 256
s_cbranch_scc1 L_end
s_and_b32 s30, s2, 7
s_lshr_b32 s31, s2, 3
v_lshrrev_b32 v3, 6, v0
v_and_b32 v2, 63, v0
s_lshl_b32 s32, s30, 2
s_lshr_b32 s33, s31, 3
s_add_u32 s32, s32, s33
s_bfe_u32 s34, s31, 0x10002
v_readfirstlane_b32 s62, v3
s_lshl_b32 s30, s34, 5
s_add_u32 s30, s30, s32
s_lshl_b32 s30, s30, 2
s_and_b32 s35, s31, 3
s_add_u32 s69, s30, s35
s_cmp_lt_u32 s62, 4
s_cbranch_scc1 L_help
v_and_b32 v1, 3, v3
v_mul_u32_u24 v1, 4096, v1
v_lshl_add_u32 v1, v2, 4, v1
s_mov_b32 s39, 0x20000
s_mov_b32 s38, 524288
s_mul_i32 s60, s31, 16384
s_and_b32 s60, s60, 0x7f000
s_lshl_b32 s30, s69, 19
s_waitcnt lgkmcnt(0)
s_add_u32 s36, s6, s30
s_addc_u32 s37, s7, 0
buffer_load_dwordx4 v[48:51], v1, s[36:39], s60 offen offset:0 nt
buffer_load_dwordx4 v[52:55], v1, s[36:39], s60 offen offset:1024 nt
buffer_load_dwordx4 v[56:59], v1, s[36:39], s60 offen offset:2048 nt
buffer_load_dwordx4 v[60:63], v1, s[36:39], s60 offen offset:3072 nt
s_add_u32 s60, s60, 16384
s_and_b32 s60, s60, 524287
buffer_load_dwordx4 v[64:67], v1, s[36:39], s60 offen offset:0 nt
buffer_load_dwordx4 v[68:71], v1, s[36:39], s60 offen offset:1024 nt
buffer_load_dwordx4 v[72:75], v1, s[36:39], s60 offen offset:2048 nt
buffer_load_dwordx4 v[76:79], v1, s[36:39], s60 offen offset:3072 nt
s_add_u32 s60, s60, 16384
s_and_b32 s60, s60, 524287
s_branch L_stream2
L_help:
v_lshrrev_b32 v40, 4, v0
v_lshlrev_b32 v40, 18, v40
v_and_b32 v36, 15, v0
v_lshlrev_b32 v37, 4, v36
v_add_u32 v40, v40, v37
s_and_b32 s74, s31, 7
s_lshl_b32 s74, s74, 1
v_add_u32 v36, s74, v36
v_and_b32 v36, 15, v36
v_and_b32 v41, 0xf0, v0
v_or_b32 v41, v41, v36
v_lshlrev_b32 v41, 2, v41
s_lshl_b32 s31, s32, 8
s_lshl_b32 s70, s34, 10
s_lshl_b32 s71, s32, 17
s_mov_b32 s47, 0x20000
s_mov_b32 s55, 0x20000
s_mov_b32 s54, 1024
s_sub_u32 s46, 0x400000, s31
s_lshl_b32 s68, s74, 14
s_waitcnt lgkmcnt(0)
s_add_u32 s52, s4, s70
s_addc_u32 s53, s5, 0
s_add_u32 s44, s10, s31
s_addc_u32 s45, s11, 0
buffer_load_dword v24, v41, s[52:55], 0 offen
buffer_load_dwordx4 v[52:55], v40, s[44:47], s68 offen
s_add_u32 s68, s68, 8192
buffer_load_dwordx4 v[56:59], v40, s[44:47], s68 offen
s_add_u32 s68, s68, 8192
buffer_load_dwordx4 v[60:63], v40, s[44:47], s68 offen
s_add_u32 s68, s68, 8192
buffer_load_dwordx4 v[64:67], v40, s[44:47], s68 offen
s_add_u32 s68, s68, 8192
s_and_b32 s68, s68, 0x3ffff
buffer_load_dwordx4 v[68:71], v40, s[44:47], s68 offen
s_add_u32 s68, s68, 8192
buffer_load_dwordx4 v[72:75], v40, s[44:47], s68 offen
s_add_u32 s68, s68, 8192
buffer_load_dwordx4 v[76:79], v40, s[44:47], s68 offen
s_add_u32 s68, s68, 8192
buffer_load_dwordx4 v[80:83], v40, s[44:47], s68 offen
s_add_u32 s68, s68, 8192
s_and_b32 s68, s68, 0x3ffff
buffer_load_dwordx4 v[84:87], v40, s[44:47], s68 offen
s_add_u32 s68, s68, 8192
buffer_load_dwordx4 v[88:91], v40, s[44:47], s68 offen
s_add_u32 s68, s68, 8192
buffer_load_dwordx4 v[92:95], v40, s[44:47], s68 offen
s_add_u32 s68, s68, 8192
buffer_load_dwordx4 v[96:99], v40, s[44:47], s68 offen
s_add_u32 s68, s68, 8192
s_and_b32 s68, s68, 0x3ffff
buffer_load_dwordx4 v[100:103], v40, s[44:47], s68 offen
s_add_u32 s68, s68, 8192
buffer_load_dwordx4 v[104:107], v40, s[44:47], s68 offen
s_add_u32 s68, s68, 8192
buffer_load_dwordx4 v[108:111], v40, s[44:47], s68 offen
s_add_u32 s68, s68, 8192
buffer_load_dwordx4 v[112:115], v40, s[44:47], s68 offen
s_add_u32 s68, s68, 8192
s_and_b32 s68, s68, 0x3ffff
buffer_load_dwordx4 v[116:119], v40, s[44:47], s68 offen
s_add_u32 s68, s68, 8192
buffer_load_dwordx4 v[120:123], v40, s[44:47], s68 offen
s_add_u32 s68, s68, 8192
buffer_load_dwordx4 v[124:127], v40, s[44:47], s68 offen
s_add_u32 s68, s68, 8192
buffer_load_dwordx4 v[128:131], v40, s[44:47], s68 offen
s_add_u32 s68, s68, 8192
s_and_b32 s68, s68, 0x3ffff
buffer_load_dwordx4 v[132:135], v40, s[44:47], s68 offen
s_add_u32 s68, s68, 8192
buffer_load_dwordx4 v[136:139], v40, s[44:47], s68 offen
s_add_u32 s68, s68, 8192
buffer_load_dwordx4 v[140:143], v40, s[44:47], s68 offen
s_add_u32 s68, s68, 8192
buffer_load_dwordx4 v[144:147], v40, s[44:47], s68 offen
s_add_u32 s68, s68, 8192
s_and_b32 s68, s68, 0x3ffff
buffer_load_dwordx4 v[148:151], v40, s[44:47], s68 offen
s_add_u32 s68, s68, 8192
buffer_load_dwordx4 v[152:155], v40, s[44:47], s68 offen
s_add_u32 s68, s68, 8192
buffer_load_dwordx4 v[156:159], v40, s[44:47], s68 offen
s_add_u32 s68, s68, 8192
buffer_load_dwordx4 v[160:163], v40, s[44:47], s68 offen
s_add_u32 s68, s68, 8192
s_and_b32 s68, s68, 0x3ffff
buffer_load_dwordx4 v[164:167], v40, s[44:47], s68 offen
s_add_u32 s68, s68, 8192
buffer_load_dwordx4 v[168:171], v40, s[44:47], s68 offen
s_add_u32 s68, s68, 8192
buffer_load_dwordx4 v[172:175], v40, s[44:47], s68 offen
s_add_u32 s68, s68, 8192
buffer_load_dwordx4 v[176:179], v40, s[44:47], s68 offen
s_add_u32 s68, s68, 8192
s_and_b32 s68, s68, 0x3ffff
s_mov_b32 s56, s28
s_mov_b32 s57, s29
s_mov_b32 s58, 1052672
s_mov_b32 s59, 0x20000
s_mov_b32 s50, 0x20000
s_mov_b32 s51, 0x20000
s_mov_b32 s63, 1040356334
s_mov_b32 s64, 0x05040100
s_mov_b32 s65, 0x07060302
s_mul_i32 s72, s62, 2176
v_lshlrev_b32 v34, 4, v2
v_add_u32 v34, s72, v34
v_lshrrev_b32 v38, 4, v2
v_mul_u32_u24 v33, 2176, v38
v_bfe_u32 v38, v36, 1, 1
v_mul_u32_u24 v38, 1088, v38
v_add_u32 v33, v33, v38
v_lshrrev_b32 v38, 2, v36
v_lshlrev_b32 v38, 4, v38
v_add_u32 v33, v33, v38
v_and_b32 v38, 1, v36
v_lshlrev_b32 v38, 3, v38
v_add_u32 v33, v33, v38
s_lshl_b32 s72, s62, 6
v_add_u32 v33, s72, v33
v_lshlrev_b32 v43, 2, v36
v_add_u32 v43, s72, v43
v_mov_b32 v8, 0
v_mov_b32 v9, 0
v_mov_b32 v10, 0
v_mov_b32 v11, 0
v_mov_b32 v12, 0
v_mov_b32 v13, 0
v_mov_b32 v14, 0
v_mov_b32 v15, 0
s_waitcnt vmcnt(28)
v_and_b32 v20, 0xffff, v24
v_lshlrev_b32 v21, 16, v24
v_lshrrev_b32 v22, 16, v24
v_and_b32 v23, 0xffff0000, v24
s_nop 1
v_dot2c_f32_bf16_dpp v8, v20, v52 row_newbcast:0 row_mask:0xf bank_mask:0xf
v_dot2c_f32_bf16_dpp v9, v21, v52 row_newbcast:0 row_mask:0xf bank_mask:0xf
v_dot2c_f32_bf16_dpp v10, v20, v53 row_newbcast:0 row_mask:0xf bank_mask:0xf
v_dot2c_f32_bf16_dpp v11, v21, v53 row_newbcast:0 row_mask:0xf bank_mask:0xf
v_dot2c_f32_bf16_dpp v12, v20, v54 row_newbcast:0 row_mask:0xf bank_mask:0xf
v_dot2c_f32_bf16_dpp v13, v21, v54 row_newbcast:0 row_mask:0xf bank_mask:0xf
v_dot2c_f32_bf16_dpp v14, v20, v55 row_newbcast:0 row_mask:0xf bank_mask:0xf
v_dot2c_f32_bf16_dpp v15, v21, v55 row_newbcast:0 row_mask:0xf bank_mask:0xf
v_dot2c_f32_bf16_dpp v8, v22, v56 row_newbcast:0 row_mask:0xf bank_mask:0xf
v_dot2c_f32_bf16_dpp v9, v23, v56 row_newbcast:0 row_mask:0xf bank_mask:0xf
v_dot2c_f32_bf16_dpp v10, v22, v57 row_newbcast:0 row_mask:0xf bank_mask:0xf
v_dot2c_f32_bf16_dpp v11, v23, v57 row_newbcast:0 row_mask:0xf bank_mask:0xf
v_dot2c_f32_bf16_dpp v12, v22, v58 row_newbcast:0 row_mask:0xf bank_mask:0xf
v_dot2c_f32_bf16_dpp v13, v23, v58 row_newbcast:0 row_mask:0xf bank_mask:0xf
v_dot2c_f32_bf16_dpp v14, v22, v59 row_newbcast:0 row_mask:0xf bank_mask:0xf
v_dot2c_f32_bf16_dpp v15, v23, v59 row_newbcast:0 row_mask:0xf bank_mask:0xf
v_dot2c_f32_bf16_dpp v8, v20, v60 row_newbcast:1 row_mask:0xf bank_mask:0xf
v_dot2c_f32_bf16_dpp v9, v21, v60 row_newbcast:1 row_mask:0xf bank_mask:0xf
v_dot2c_f32_bf16_dpp v10, v20, v61 row_newbcast:1 row_mask:0xf bank_mask:0xf
v_dot2c_f32_bf16_dpp v11, v21, v61 row_newbcast:1 row_mask:0xf bank_mask:0xf
v_dot2c_f32_bf16_dpp v12, v20, v62 row_newbcast:1 row_mask:0xf bank_mask:0xf
v_dot2c_f32_bf16_dpp v13, v21, v62 row_newbcast:1 row_mask:0xf bank_mask:0xf
v_dot2c_f32_bf16_dpp v14, v20, v63 row_newbcast:1 row_mask:0xf bank_mask:0xf
v_dot2c_f32_bf16_dpp v15, v21, v63 row_newbcast:1 row_mask:0xf bank_mask:0xf
v_dot2c_f32_bf16_dpp v8, v22, v64 row_newbcast:1 row_mask:0xf bank_mask:0xf
v_dot2c_f32_bf16_dpp v9, v23, v64 row_newbcast:1 row_mask:0xf bank_mask:0xf
v_dot2c_f32_bf16_dpp v10, v22, v65 row_newbcast:1 row_mask:0xf bank_mask:0xf
v_dot2c_f32_bf16_dpp v11, v23, v65 row_newbcast:1 row_mask:0xf bank_mask:0xf
v_dot2c_f32_bf16_dpp v12, v22, v66 row_newbcast:1 row_mask:0xf bank_mask:0xf
v_dot2c_f32_bf16_dpp v13, v23, v66 row_newbcast:1 row_mask:0xf bank_mask:0xf
v_dot2c_f32_bf16_dpp v14, v22, v67 row_newbcast:1 row_mask:0xf bank_mask:0xf
v_dot2c_f32_bf16_dpp v15, v23, v67 row_newbcast:1 row_mask:0xf bank_mask:0xf
s_waitcnt vmcnt(24)
v_dot2c_f32_bf16_dpp v8, v20, v68 row_newbcast:2 row_mask:0xf bank_mask:0xf
v_dot2c_f32_bf16_dpp v9, v21, v68 row_newbcast:2 row_mask:0xf bank_mask:0xf
v_dot2c_f32_bf16_dpp v10, v20, v69 row_newbcast:2 row_mask:0xf bank_mask:0xf
v_dot2c_f32_bf16_dpp v11, v21, v69 row_newbcast:2 row_mask:0xf bank_mask:0xf
v_dot2c_f32_bf16_dpp v12, v20, v70 row_newbcast:2 row_mask:0xf bank_mask:0xf
v_dot2c_f32_bf16_dpp v13, v21, v70 row_newbcast:2 row_mask:0xf bank_mask:0xf
v_dot2c_f32_bf16_dpp v14, v20, v71 row_newbcast:2 row_mask:0xf bank_mask:0xf
v_dot2c_f32_bf16_dpp v15, v21, v71 row_newbcast:2 row_mask:0xf bank_mask:0xf
v_dot2c_f32_bf16_dpp v8, v22, v72 row_newbcast:2 row_mask:0xf bank_mask:0xf
v_dot2c_f32_bf16_dpp v9, v23, v72 row_newbcast:2 row_mask:0xf bank_mask:0xf
v_dot2c_f32_bf16_dpp v10, v22, v73 row_newbcast:2 row_mask:0xf bank_mask:0xf
v_dot2c_f32_bf16_dpp v11, v23, v73 row_newbcast:2 row_mask:0xf bank_mask:0xf
v_dot2c_f32_bf16_dpp v12, v22, v74 row_newbcast:2 row_mask:0xf bank_mask:0xf
v_dot2c_f32_bf16_dpp v13, v23, v74 row_newbcast:2 row_mask:0xf bank_mask:0xf
v_dot2c_f32_bf16_dpp v14, v22, v75 row_newbcast:2 row_mask:0xf bank_mask:0xf
v_dot2c_f32_bf16_dpp v15, v23, v75 row_newbcast:2 row_mask:0xf bank_mask:0xf
v_dot2c_f32_bf16_dpp v8, v20, v76 row_newbcast:3 row_mask:0xf bank_mask:0xf
v_dot2c_f32_bf16_dpp v9, v21, v76 row_newbcast:3 row_mask:0xf bank_mask:0xf
v_dot2c_f32_bf16_dpp v10, v20, v77 row_newbcast:3 row_mask:0xf bank_mask:0xf
v_dot2c_f32_bf16_dpp v11, v21, v77 row_newbcast:3 row_mask:0xf bank_mask:0xf
v_dot2c_f32_bf16_dpp v12, v20, v78 row_newbcast:3 row_mask:0xf bank_mask:0xf
v_dot2c_f32_bf16_dpp v13, v21, v78 row_newbcast:3 row_mask:0xf bank_mask:0xf
v_dot2c_f32_bf16_dpp v14, v20, v79 row_newbcast:3 row_mask:0xf bank_mask:0xf
v_dot2c_f32_bf16_dpp v15, v21, v79 row_newbcast:3 row_mask:0xf bank_mask:0xf
v_dot2c_f32_bf16_dpp v8, v22, v80 row_newbcast:3 row_mask:0xf bank_mask:0xf
v_dot2c_f32_bf16_dpp v9, v23, v80 row_newbcast:3 row_mask:0xf bank_mask:0xf
v_dot2c_f32_bf16_dpp v10, v22, v81 row_newbcast:3 row_mask:0xf bank_mask:0xf
v_dot2c_f32_bf16_dpp v11, v23, v81 row_newbcast:3 row_mask:0xf bank_mask:0xf
v_dot2c_f32_bf16_dpp v12, v22, v82 row_newbcast:3 row_mask:0xf bank_mask:0xf
v_dot2c_f32_bf16_dpp v13, v23, v82 row_newbcast:3 row_mask:0xf bank_mask:0xf
v_dot2c_f32_bf16_dpp v14, v22, v83 row_newbcast:3 row_mask:0xf bank_mask:0xf
v_dot2c_f32_bf16_dpp v15, v23, v83 row_newbcast:3 row_mask:0xf bank_mask:0xf
s_waitcnt vmcnt(20)
v_dot2c_f32_bf16_dpp v8, v20, v84 row_newbcast:4 row_mask:0xf bank_mask:0xf
v_dot2c_f32_bf16_dpp v9, v21, v84 row_newbcast:4 row_mask:0xf bank_mask:0xf
v_dot2c_f32_bf16_dpp v10, v20, v85 row_newbcast:4 row_mask:0xf bank_mask:0xf
v_dot2c_f32_bf16_dpp v11, v21, v85 row_newbcast:4 row_mask:0xf bank_mask:0xf
v_dot2c_f32_bf16_dpp v12, v20, v86 row_newbcast:4 row_mask:0xf bank_mask:0xf
v_dot2c_f32_bf16_dpp v13, v21, v86 row_newbcast:4 row_mask:0xf bank_mask:0xf
v_dot2c_f32_bf16_dpp v14, v20, v87 row_newbcast:4 row_mask:0xf bank_mask:0xf
v_dot2c_f32_bf16_dpp v15, v21, v87 row_newbcast:4 row_mask:0xf bank_mask:0xf
v_dot2c_f32_bf16_dpp v8, v22, v88 row_newbcast:4 row_mask:0xf bank_mask:0xf
v_dot2c_f32_bf16_dpp v9, v23, v88 row_newbcast:4 row_mask:0xf bank_mask:0xf
v_dot2c_f32_bf16_dpp v10, v22, v89 row_newbcast:4 row_mask:0xf bank_mask:0xf
v_dot2c_f32_bf16_dpp v11, v23, v89 row_newbcast:4 row_mask:0xf bank_mask:0xf
v_dot2c_f32_bf16_dpp v12, v22, v90 row_newbcast:4 row_mask:0xf bank_mask:0xf
v_dot2c_f32_bf16_dpp v13, v23, v90 row_newbcast:4 row_mask:0xf bank_mask:0xf
v_dot2c_f32_bf16_dpp v14, v22, v91 row_newbcast:4 row_mask:0xf bank_mask:0xf
v_dot2c_f32_bf16_dpp v15, v23, v91 row_newbcast:4 row_mask:0xf bank_mask:0xf
v_dot2c_f32_bf16_dpp v8, v20, v92 row_newbcast:5 row_mask:0xf bank_mask:0xf
v_dot2c_f32_bf16_dpp v9, v21, v92 row_newbcast:5 row_mask:0xf bank_mask:0xf
v_dot2c_f32_bf16_dpp v10, v20, v93 row_newbcast:5 row_mask:0xf bank_mask:0xf
v_dot2c_f32_bf16_dpp v11, v21, v93 row_newbcast:5 row_mask:0xf bank_mask:0xf
v_dot2c_f32_bf16_dpp v12, v20, v94 row_newbcast:5 row_mask:0xf bank_mask:0xf
v_dot2c_f32_bf16_dpp v13, v21, v94 row_newbcast:5 row_mask:0xf bank_mask:0xf
v_dot2c_f32_bf16_dpp v14, v20, v95 row_newbcast:5 row_mask:0xf bank_mask:0xf
v_dot2c_f32_bf16_dpp v15, v21, v95 row_newbcast:5 row_mask:0xf bank_mask:0xf
v_dot2c_f32_bf16_dpp v8, v22, v96 row_newbcast:5 row_mask:0xf bank_mask:0xf
v_dot2c_f32_bf16_dpp v9, v23, v96 row_newbcast:5 row_mask:0xf bank_mask:0xf
v_dot2c_f32_bf16_dpp v10, v22, v97 row_newbcast:5 row_mask:0xf bank_mask:0xf
v_dot2c_f32_bf16_dpp v11, v23, v97 row_newbcast:5 row_mask:0xf bank_mask:0xf
v_dot2c_f32_bf16_dpp v12, v22, v98 row_newbcast:5 row_mask:0xf bank_mask:0xf
v_dot2c_f32_bf16_dpp v13, v23, v98 row_newbcast:5 row_mask:0xf bank_mask:0xf
v_dot2c_f32_bf16_dpp v14, v22, v99 row_newbcast:5 row_mask:0xf bank_mask:0xf
v_dot2c_f32_bf16_dpp v15, v23, v99 row_newbcast:5 row_mask:0xf bank_mask:0xf
s_waitcnt vmcnt(16)
v_dot2c_f32_bf16_dpp v8, v20, v100 row_newbcast:6 row_mask:0xf bank_mask:0xf
v_dot2c_f32_bf16_dpp v9, v21, v100 row_newbcast:6 row_mask:0xf bank_mask:0xf
v_dot2c_f32_bf16_dpp v10, v20, v101 row_newbcast:6 row_mask:0xf bank_mask:0xf
v_dot2c_f32_bf16_dpp v11, v21, v101 row_newbcast:6 row_mask:0xf bank_mask:0xf
v_dot2c_f32_bf16_dpp v12, v20, v102 row_newbcast:6 row_mask:0xf bank_mask:0xf
v_dot2c_f32_bf16_dpp v13, v21, v102 row_newbcast:6 row_mask:0xf bank_mask:0xf
v_dot2c_f32_bf16_dpp v14, v20, v103 row_newbcast:6 row_mask:0xf bank_mask:0xf
v_dot2c_f32_bf16_dpp v15, v21, v103 row_newbcast:6 row_mask:0xf bank_mask:0xf
v_dot2c_f32_bf16_dpp v8, v22, v104 row_newbcast:6 row_mask:0xf bank_mask:0xf
v_dot2c_f32_bf16_dpp v9, v23, v104 row_newbcast:6 row_mask:0xf bank_mask:0xf
v_dot2c_f32_bf16_dpp v10, v22, v105 row_newbcast:6 row_mask:0xf bank_mask:0xf
v_dot2c_f32_bf16_dpp v11, v23, v105 row_newbcast:6 row_mask:0xf bank_mask:0xf
v_dot2c_f32_bf16_dpp v12, v22, v106 row_newbcast:6 row_mask:0xf bank_mask:0xf
v_dot2c_f32_bf16_dpp v13, v23, v106 row_newbcast:6 row_mask:0xf bank_mask:0xf
v_dot2c_f32_bf16_dpp v14, v22, v107 row_newbcast:6 row_mask:0xf bank_mask:0xf
v_dot2c_f32_bf16_dpp v15, v23, v107 row_newbcast:6 row_mask:0xf bank_mask:0xf
v_dot2c_f32_bf16_dpp v8, v20, v108 row_newbcast:7 row_mask:0xf bank_mask:0xf
v_dot2c_f32_bf16_dpp v9, v21, v108 row_newbcast:7 row_mask:0xf bank_mask:0xf
v_dot2c_f32_bf16_dpp v10, v20, v109 row_newbcast:7 row_mask:0xf bank_mask:0xf
v_dot2c_f32_bf16_dpp v11, v21, v109 row_newbcast:7 row_mask:0xf bank_mask:0xf
v_dot2c_f32_bf16_dpp v12, v20, v110 row_newbcast:7 row_mask:0xf bank_mask:0xf
v_dot2c_f32_bf16_dpp v13, v21, v110 row_newbcast:7 row_mask:0xf bank_mask:0xf
v_dot2c_f32_bf16_dpp v14, v20, v111 row_newbcast:7 row_mask:0xf bank_mask:0xf
v_dot2c_f32_bf16_dpp v15, v21, v111 row_newbcast:7 row_mask:0xf bank_mask:0xf
v_dot2c_f32_bf16_dpp v8, v22, v112 row_newbcast:7 row_mask:0xf bank_mask:0xf
v_dot2c_f32_bf16_dpp v9, v23, v112 row_newbcast:7 row_mask:0xf bank_mask:0xf
v_dot2c_f32_bf16_dpp v10, v22, v113 row_newbcast:7 row_mask:0xf bank_mask:0xf
v_dot2c_f32_bf16_dpp v11, v23, v113 row_newbcast:7 row_mask:0xf bank_mask:0xf
v_dot2c_f32_bf16_dpp v12, v22, v114 row_newbcast:7 row_mask:0xf bank_mask:0xf
v_dot2c_f32_bf16_dpp v13, v23, v114 row_newbcast:7 row_mask:0xf bank_mask:0xf
v_dot2c_f32_bf16_dpp v14, v22, v115 row_newbcast:7 row_mask:0xf bank_mask:0xf
v_dot2c_f32_bf16_dpp v15, v23, v115 row_newbcast:7 row_mask:0xf bank_mask:0xf
s_waitcnt vmcnt(12)
v_dot2c_f32_bf16_dpp v8, v20, v116 row_newbcast:8 row_mask:0xf bank_mask:0xf
v_dot2c_f32_bf16_dpp v9, v21, v116 row_newbcast:8 row_mask:0xf bank_mask:0xf
v_dot2c_f32_bf16_dpp v10, v20, v117 row_newbcast:8 row_mask:0xf bank_mask:0xf
v_dot2c_f32_bf16_dpp v11, v21, v117 row_newbcast:8 row_mask:0xf bank_mask:0xf
v_dot2c_f32_bf16_dpp v12, v20, v118 row_newbcast:8 row_mask:0xf bank_mask:0xf
v_dot2c_f32_bf16_dpp v13, v21, v118 row_newbcast:8 row_mask:0xf bank_mask:0xf
v_dot2c_f32_bf16_dpp v14, v20, v119 row_newbcast:8 row_mask:0xf bank_mask:0xf
v_dot2c_f32_bf16_dpp v15, v21, v119 row_newbcast:8 row_mask:0xf bank_mask:0xf
v_dot2c_f32_bf16_dpp v8, v22, v120 row_newbcast:8 row_mask:0xf bank_mask:0xf
v_dot2c_f32_bf16_dpp v9, v23, v120 row_newbcast:8 row_mask:0xf bank_mask:0xf
v_dot2c_f32_bf16_dpp v10, v22, v121 row_newbcast:8 row_mask:0xf bank_mask:0xf
v_dot2c_f32_bf16_dpp v11, v23, v121 row_newbcast:8 row_mask:0xf bank_mask:0xf
v_dot2c_f32_bf16_dpp v12, v22, v122 row_newbcast:8 row_mask:0xf bank_mask:0xf
v_dot2c_f32_bf16_dpp v13, v23, v122 row_newbcast:8 row_mask:0xf bank_mask:0xf
v_dot2c_f32_bf16_dpp v14, v22, v123 row_newbcast:8 row_mask:0xf bank_mask:0xf
v_dot2c_f32_bf16_dpp v15, v23, v123 row_newbcast:8 row_mask:0xf bank_mask:0xf
v_dot2c_f32_bf16_dpp v8, v20, v124 row_newbcast:9 row_mask:0xf bank_mask:0xf
v_dot2c_f32_bf16_dpp v9, v21, v124 row_newbcast:9 row_mask:0xf bank_mask:0xf
v_dot2c_f32_bf16_dpp v10, v20, v125 row_newbcast:9 row_mask:0xf bank_mask:0xf
v_dot2c_f32_bf16_dpp v11, v21, v125 row_newbcast:9 row_mask:0xf bank_mask:0xf
v_dot2c_f32_bf16_dpp v12, v20, v126 row_newbcast:9 row_mask:0xf bank_mask:0xf
v_dot2c_f32_bf16_dpp v13, v21, v126 row_newbcast:9 row_mask:0xf bank_mask:0xf
v_dot2c_f32_bf16_dpp v14, v20, v127 row_newbcast:9 row_mask:0xf bank_mask:0xf
v_dot2c_f32_bf16_dpp v15, v21, v127 row_newbcast:9 row_mask:0xf bank_mask:0xf
v_dot2c_f32_bf16_dpp v8, v22, v128 row_newbcast:9 row_mask:0xf bank_mask:0xf
v_dot2c_f32_bf16_dpp v9, v23, v128 row_newbcast:9 row_mask:0xf bank_mask:0xf
v_dot2c_f32_bf16_dpp v10, v22, v129 row_newbcast:9 row_mask:0xf bank_mask:0xf
v_dot2c_f32_bf16_dpp v11, v23, v129 row_newbcast:9 row_mask:0xf bank_mask:0xf
v_dot2c_f32_bf16_dpp v12, v22, v130 row_newbcast:9 row_mask:0xf bank_mask:0xf
v_dot2c_f32_bf16_dpp v13, v23, v130 row_newbcast:9 row_mask:0xf bank_mask:0xf
v_dot2c_f32_bf16_dpp v14, v22, v131 row_newbcast:9 row_mask:0xf bank_mask:0xf
v_dot2c_f32_bf16_dpp v15, v23, v131 row_newbcast:9 row_mask:0xf bank_mask:0xf
s_waitcnt vmcnt(8)
v_dot2c_f32_bf16_dpp v8, v20, v132 row_newbcast:10 row_mask:0xf bank_mask:0xf
v_dot2c_f32_bf16_dpp v9, v21, v132 row_newbcast:10 row_mask:0xf bank_mask:0xf
v_dot2c_f32_bf16_dpp v10, v20, v133 row_newbcast:10 row_mask:0xf bank_mask:0xf
v_dot2c_f32_bf16_dpp v11, v21, v133 row_newbcast:10 row_mask:0xf bank_mask:0xf
v_dot2c_f32_bf16_dpp v12, v20, v134 row_newbcast:10 row_mask:0xf bank_mask:0xf
v_dot2c_f32_bf16_dpp v13, v21, v134 row_newbcast:10 row_mask:0xf bank_mask:0xf
v_dot2c_f32_bf16_dpp v14, v20, v135 row_newbcast:10 row_mask:0xf bank_mask:0xf
v_dot2c_f32_bf16_dpp v15, v21, v135 row_newbcast:10 row_mask:0xf bank_mask:0xf
v_dot2c_f32_bf16_dpp v8, v22, v136 row_newbcast:10 row_mask:0xf bank_mask:0xf
v_dot2c_f32_bf16_dpp v9, v23, v136 row_newbcast:10 row_mask:0xf bank_mask:0xf
v_dot2c_f32_bf16_dpp v10, v22, v137 row_newbcast:10 row_mask:0xf bank_mask:0xf
v_dot2c_f32_bf16_dpp v11, v23, v137 row_newbcast:10 row_mask:0xf bank_mask:0xf
v_dot2c_f32_bf16_dpp v12, v22, v138 row_newbcast:10 row_mask:0xf bank_mask:0xf
v_dot2c_f32_bf16_dpp v13, v23, v138 row_newbcast:10 row_mask:0xf bank_mask:0xf
v_dot2c_f32_bf16_dpp v14, v22, v139 row_newbcast:10 row_mask:0xf bank_mask:0xf
v_dot2c_f32_bf16_dpp v15, v23, v139 row_newbcast:10 row_mask:0xf bank_mask:0xf
v_dot2c_f32_bf16_dpp v8, v20, v140 row_newbcast:11 row_mask:0xf bank_mask:0xf
v_dot2c_f32_bf16_dpp v9, v21, v140 row_newbcast:11 row_mask:0xf bank_mask:0xf
v_dot2c_f32_bf16_dpp v10, v20, v141 row_newbcast:11 row_mask:0xf bank_mask:0xf
v_dot2c_f32_bf16_dpp v11, v21, v141 row_newbcast:11 row_mask:0xf bank_mask:0xf
v_dot2c_f32_bf16_dpp v12, v20, v142 row_newbcast:11 row_mask:0xf bank_mask:0xf
v_dot2c_f32_bf16_dpp v13, v21, v142 row_newbcast:11 row_mask:0xf bank_mask:0xf
v_dot2c_f32_bf16_dpp v14, v20, v143 row_newbcast:11 row_mask:0xf bank_mask:0xf
v_dot2c_f32_bf16_dpp v15, v21, v143 row_newbcast:11 row_mask:0xf bank_mask:0xf
v_dot2c_f32_bf16_dpp v8, v22, v144 row_newbcast:11 row_mask:0xf bank_mask:0xf
v_dot2c_f32_bf16_dpp v9, v23, v144 row_newbcast:11 row_mask:0xf bank_mask:0xf
v_dot2c_f32_bf16_dpp v10, v22, v145 row_newbcast:11 row_mask:0xf bank_mask:0xf
v_dot2c_f32_bf16_dpp v11, v23, v145 row_newbcast:11 row_mask:0xf bank_mask:0xf
v_dot2c_f32_bf16_dpp v12, v22, v146 row_newbcast:11 row_mask:0xf bank_mask:0xf
v_dot2c_f32_bf16_dpp v13, v23, v146 row_newbcast:11 row_mask:0xf bank_mask:0xf
v_dot2c_f32_bf16_dpp v14, v22, v147 row_newbcast:11 row_mask:0xf bank_mask:0xf
v_dot2c_f32_bf16_dpp v15, v23, v147 row_newbcast:11 row_mask:0xf bank_mask:0xf
s_waitcnt vmcnt(4)
v_dot2c_f32_bf16_dpp v8, v20, v148 row_newbcast:12 row_mask:0xf bank_mask:0xf
v_dot2c_f32_bf16_dpp v9, v21, v148 row_newbcast:12 row_mask:0xf bank_mask:0xf
v_dot2c_f32_bf16_dpp v10, v20, v149 row_newbcast:12 row_mask:0xf bank_mask:0xf
v_dot2c_f32_bf16_dpp v11, v21, v149 row_newbcast:12 row_mask:0xf bank_mask:0xf
v_dot2c_f32_bf16_dpp v12, v20, v150 row_newbcast:12 row_mask:0xf bank_mask:0xf
v_dot2c_f32_bf16_dpp v13, v21, v150 row_newbcast:12 row_mask:0xf bank_mask:0xf
v_dot2c_f32_bf16_dpp v14, v20, v151 row_newbcast:12 row_mask:0xf bank_mask:0xf
v_dot2c_f32_bf16_dpp v15, v21, v151 row_newbcast:12 row_mask:0xf bank_mask:0xf
v_dot2c_f32_bf16_dpp v8, v22, v152 row_newbcast:12 row_mask:0xf bank_mask:0xf
v_dot2c_f32_bf16_dpp v9, v23, v152 row_newbcast:12 row_mask:0xf bank_mask:0xf
v_dot2c_f32_bf16_dpp v10, v22, v153 row_newbcast:12 row_mask:0xf bank_mask:0xf
v_dot2c_f32_bf16_dpp v11, v23, v153 row_newbcast:12 row_mask:0xf bank_mask:0xf
v_dot2c_f32_bf16_dpp v12, v22, v154 row_newbcast:12 row_mask:0xf bank_mask:0xf
v_dot2c_f32_bf16_dpp v13, v23, v154 row_newbcast:12 row_mask:0xf bank_mask:0xf
v_dot2c_f32_bf16_dpp v14, v22, v155 row_newbcast:12 row_mask:0xf bank_mask:0xf
v_dot2c_f32_bf16_dpp v15, v23, v155 row_newbcast:12 row_mask:0xf bank_mask:0xf
v_dot2c_f32_bf16_dpp v8, v20, v156 row_newbcast:13 row_mask:0xf bank_mask:0xf
v_dot2c_f32_bf16_dpp v9, v21, v156 row_newbcast:13 row_mask:0xf bank_mask:0xf
v_dot2c_f32_bf16_dpp v10, v20, v157 row_newbcast:13 row_mask:0xf bank_mask:0xf
v_dot2c_f32_bf16_dpp v11, v21, v157 row_newbcast:13 row_mask:0xf bank_mask:0xf
v_dot2c_f32_bf16_dpp v12, v20, v158 row_newbcast:13 row_mask:0xf bank_mask:0xf
v_dot2c_f32_bf16_dpp v13, v21, v158 row_newbcast:13 row_mask:0xf bank_mask:0xf
v_dot2c_f32_bf16_dpp v14, v20, v159 row_newbcast:13 row_mask:0xf bank_mask:0xf
v_dot2c_f32_bf16_dpp v15, v21, v159 row_newbcast:13 row_mask:0xf bank_mask:0xf
v_dot2c_f32_bf16_dpp v8, v22, v160 row_newbcast:13 row_mask:0xf bank_mask:0xf
v_dot2c_f32_bf16_dpp v9, v23, v160 row_newbcast:13 row_mask:0xf bank_mask:0xf
v_dot2c_f32_bf16_dpp v10, v22, v161 row_newbcast:13 row_mask:0xf bank_mask:0xf
v_dot2c_f32_bf16_dpp v11, v23, v161 row_newbcast:13 row_mask:0xf bank_mask:0xf
v_dot2c_f32_bf16_dpp v12, v22, v162 row_newbcast:13 row_mask:0xf bank_mask:0xf
v_dot2c_f32_bf16_dpp v13, v23, v162 row_newbcast:13 row_mask:0xf bank_mask:0xf
v_dot2c_f32_bf16_dpp v14, v22, v163 row_newbcast:13 row_mask:0xf bank_mask:0xf
v_dot2c_f32_bf16_dpp v15, v23, v163 row_newbcast:13 row_mask:0xf bank_mask:0xf
s_waitcnt vmcnt(0)
v_dot2c_f32_bf16_dpp v8, v20, v164 row_newbcast:14 row_mask:0xf bank_mask:0xf
v_dot2c_f32_bf16_dpp v9, v21, v164 row_newbcast:14 row_mask:0xf bank_mask:0xf
v_dot2c_f32_bf16_dpp v10, v20, v165 row_newbcast:14 row_mask:0xf bank_mask:0xf
v_dot2c_f32_bf16_dpp v11, v21, v165 row_newbcast:14 row_mask:0xf bank_mask:0xf
v_dot2c_f32_bf16_dpp v12, v20, v166 row_newbcast:14 row_mask:0xf bank_mask:0xf
v_dot2c_f32_bf16_dpp v13, v21, v166 row_newbcast:14 row_mask:0xf bank_mask:0xf
v_dot2c_f32_bf16_dpp v14, v20, v167 row_newbcast:14 row_mask:0xf bank_mask:0xf
v_dot2c_f32_bf16_dpp v15, v21, v167 row_newbcast:14 row_mask:0xf bank_mask:0xf
v_dot2c_f32_bf16_dpp v8, v22, v168 row_newbcast:14 row_mask:0xf bank_mask:0xf
v_dot2c_f32_bf16_dpp v9, v23, v168 row_newbcast:14 row_mask:0xf bank_mask:0xf
v_dot2c_f32_bf16_dpp v10, v22, v169 row_newbcast:14 row_mask:0xf bank_mask:0xf
v_dot2c_f32_bf16_dpp v11, v23, v169 row_newbcast:14 row_mask:0xf bank_mask:0xf
v_dot2c_f32_bf16_dpp v12, v22, v170 row_newbcast:14 row_mask:0xf bank_mask:0xf
v_dot2c_f32_bf16_dpp v13, v23, v170 row_newbcast:14 row_mask:0xf bank_mask:0xf
v_dot2c_f32_bf16_dpp v14, v22, v171 row_newbcast:14 row_mask:0xf bank_mask:0xf
v_dot2c_f32_bf16_dpp v15, v23, v171 row_newbcast:14 row_mask:0xf bank_mask:0xf
v_dot2c_f32_bf16_dpp v8, v20, v172 row_newbcast:15 row_mask:0xf bank_mask:0xf
v_dot2c_f32_bf16_dpp v9, v21, v172 row_newbcast:15 row_mask:0xf bank_mask:0xf
v_dot2c_f32_bf16_dpp v10, v20, v173 row_newbcast:15 row_mask:0xf bank_mask:0xf
v_dot2c_f32_bf16_dpp v11, v21, v173 row_newbcast:15 row_mask:0xf bank_mask:0xf
v_dot2c_f32_bf16_dpp v12, v20, v174 row_newbcast:15 row_mask:0xf bank_mask:0xf
v_dot2c_f32_bf16_dpp v13, v21, v174 row_newbcast:15 row_mask:0xf bank_mask:0xf
v_dot2c_f32_bf16_dpp v14, v20, v175 row_newbcast:15 row_mask:0xf bank_mask:0xf
v_dot2c_f32_bf16_dpp v15, v21, v175 row_newbcast:15 row_mask:0xf bank_mask:0xf
v_dot2c_f32_bf16_dpp v8, v22, v176 row_newbcast:15 row_mask:0xf bank_mask:0xf
v_dot2c_f32_bf16_dpp v9, v23, v176 row_newbcast:15 row_mask:0xf bank_mask:0xf
v_dot2c_f32_bf16_dpp v10, v22, v177 row_newbcast:15 row_mask:0xf bank_mask:0xf
v_dot2c_f32_bf16_dpp v11, v23, v177 row_newbcast:15 row_mask:0xf bank_mask:0xf
v_dot2c_f32_bf16_dpp v12, v22, v178 row_newbcast:15 row_mask:0xf bank_mask:0xf
v_dot2c_f32_bf16_dpp v13, v23, v178 row_newbcast:15 row_mask:0xf bank_mask:0xf
v_dot2c_f32_bf16_dpp v14, v22, v179 row_newbcast:15 row_mask:0xf bank_mask:0xf
v_dot2c_f32_bf16_dpp v15, v23, v179 row_newbcast:15 row_mask:0xf bank_mask:0xf
s_nop 2
ds_write_b128 v34, v[8:11] offset:8704
ds_write_b128 v34, v[12:15] offset:9792
s_waitcnt lgkmcnt(0)
s_barrier
ds_read_b64 v[16:17], v33 offset:8704
ds_read_b64 v[18:19], v33 offset:8960
ds_read_b64 v[20:21], v33 offset:9216
ds_read_b64 v[22:23], v33 offset:9472
s_waitcnt lgkmcnt(2)
v_add_f32 v16, v16, v18
v_add_f32 v17, v17, v19
s_waitcnt lgkmcnt(0)
v_add_f32 v20, v20, v22
v_add_f32 v21, v21, v23
v_add_f32 v16, v16, v20
v_add_f32 v17, v17, v21
v_mov_b32 v18, v16
v_mov_b32 v19, v17
s_nop 0
v_permlane16_swap_b32 v16, v18
v_permlane16_swap_b32 v17, v19
s_nop 0
v_add_f32 v16, v16, v18
v_add_f32 v17, v17, v19
v_mov_b32 v18, v16
v_mov_b32 v19, v17
s_nop 0
v_permlane32_swap_b32 v16, v18
v_permlane32_swap_b32 v17, v19
s_nop 0
v_add_f32 v16, v16, v18
v_add_f32 v17, v17, v19
v_cvt_pk_bf16_f32 v24, v16, v17
ds_write_b32 v43, v24 offset:17408
s_add_u32 s52, s14, s70
s_addc_u32 s53, s15, 0
s_add_u32 s44, s20, s31
s_addc_u32 s45, s21, 0
s_waitcnt lgkmcnt(0)
s_barrier
buffer_load_dword v24, v41, s[52:55], 0 offen
buffer_load_dwordx4 v[52:55], v40, s[44:47], s68 offen
s_add_u32 s68, s68, 8192
buffer_load_dwordx4 v[56:59], v40, s[44:47], s68 offen
s_add_u32 s68, s68, 8192
buffer_load_dwordx4 v[60:63], v40, s[44:47], s68 offen
s_add_u32 s68, s68, 8192
buffer_load_dwordx4 v[64:67], v40, s[44:47], s68 offen
s_add_u32 s68, s68, 8192
s_and_b32 s68, s68, 0x3ffff
buffer_load_dwordx4 v[68:71], v40, s[44:47], s68 offen
s_add_u32 s68, s68, 8192
buffer_load_dwordx4 v[72:75], v40, s[44:47], s68 offen
s_add_u32 s68, s68, 8192
buffer_load_dwordx4 v[76:79], v40, s[44:47], s68 offen
s_add_u32 s68, s68, 8192
buffer_load_dwordx4 v[80:83], v40, s[44:47], s68 offen
s_add_u32 s68, s68, 8192
s_and_b32 s68, s68, 0x3ffff
buffer_load_dwordx4 v[84:87], v40, s[44:47], s68 offen
s_add_u32 s68, s68, 8192
buffer_load_dwordx4 v[88:91], v40, s[44:47], s68 offen
s_add_u32 s68, s68, 8192
buffer_load_dwordx4 v[92:95], v40, s[44:47], s68 offen
s_add_u32 s68, s68, 8192
buffer_load_dwordx4 v[96:99], v40, s[44:47], s68 offen
s_add_u32 s68, s68, 8192
s_and_b32 s68, s68, 0x3ffff
buffer_load_dwordx4 v[100:103], v40, s[44:47], s68 offen
s_add_u32 s68, s68, 8192
buffer_load_dwordx4 v[104:107], v40, s[44:47], s68 offen
s_add_u32 s68, s68, 8192
buffer_load_dwordx4 v[108:111], v40, s[44:47], s68 offen
s_add_u32 s68, s68, 8192
buffer_load_dwordx4 v[112:115], v40, s[44:47], s68 offen
s_add_u32 s68, s68, 8192
s_and_b32 s68, s68, 0x3ffff
buffer_load_dwordx4 v[116:119], v40, s[44:47], s68 offen
s_add_u32 s68, s68, 8192
buffer_load_dwordx4 v[120:123], v40, s[44:47], s68 offen
s_add_u32 s68, s68, 8192
buffer_load_dwordx4 v[124:127], v40, s[44:47], s68 offen
s_add_u32 s68, s68, 8192
buffer_load_dwordx4 v[128:131], v40, s[44:47], s68 offen
s_add_u32 s68, s68, 8192
s_and_b32 s68, s68, 0x3ffff
buffer_load_dwordx4 v[132:135], v40, s[44:47], s68 offen
s_add_u32 s68, s68, 8192
buffer_load_dwordx4 v[136:139], v40, s[44:47], s68 offen
s_add_u32 s68, s68, 8192
buffer_load_dwordx4 v[140:143], v40, s[44:47], s68 offen
s_add_u32 s68, s68, 8192
buffer_load_dwordx4 v[144:147], v40, s[44:47], s68 offen
s_add_u32 s68, s68, 8192
s_and_b32 s68, s68, 0x3ffff
buffer_load_dwordx4 v[148:151], v40, s[44:47], s68 offen
s_add_u32 s68, s68, 8192
buffer_load_dwordx4 v[152:155], v40, s[44:47], s68 offen
s_add_u32 s68, s68, 8192
buffer_load_dwordx4 v[156:159], v40, s[44:47], s68 offen
s_add_u32 s68, s68, 8192
buffer_load_dwordx4 v[160:163], v40, s[44:47], s68 offen
s_add_u32 s68, s68, 8192
s_and_b32 s68, s68, 0x3ffff
buffer_load_dwordx4 v[164:167], v40, s[44:47], s68 offen
s_add_u32 s68, s68, 8192
buffer_load_dwordx4 v[168:171], v40, s[44:47], s68 offen
s_add_u32 s68, s68, 8192
buffer_load_dwordx4 v[172:175], v40, s[44:47], s68 offen
s_add_u32 s68, s68, 8192
buffer_load_dwordx4 v[176:179], v40, s[44:47], s68 offen
s_add_u32 s68, s68, 8192
s_and_b32 s68, s68, 0x3ffff
s_lshl_b32 s75, s62, 15
v_lshlrev_b32 v42, 4, v2
v_add_u32 v42, s75, v42
s_mul_i32 s73, s62, 2304
v_lshlrev_b32 v44, 4, v2
v_add_u32 v44, s73, v44
v_bfe_u32 v45, v0, 1, 1
v_mul_u32_u24 v45, 1152, v45
v_lshrrev_b32 v38, 2, v0
v_lshlrev_b32 v38, 4, v38
v_add_u32 v45, v45, v38
v_and_b32 v38, 1, v0
v_lshlrev_b32 v38, 3, v38
v_add_u32 v45, v45, v38
v_lshlrev_b32 v46, 3, v0
v_and_b32 v47, 15, v0
v_lshlrev_b32 v47, 2, v47
v_mov_b32 v38, 0
v_mov_b32 v8, 0
v_mov_b32 v9, 0
v_mov_b32 v10, 0
v_mov_b32 v11, 0
v_mov_b32 v12, 0
v_mov_b32 v13, 0
v_mov_b32 v14, 0
v_mov_b32 v15, 0
s_waitcnt vmcnt(28)
v_and_b32 v20, 0xffff, v24
v_lshlrev_b32 v21, 16, v24
v_lshrrev_b32 v22, 16, v24
v_and_b32 v23, 0xffff0000, v24
s_nop 1
v_dot2c_f32_bf16_dpp v8, v20, v52 row_newbcast:0 row_mask:0xf bank_mask:0xf
v_dot2c_f32_bf16_dpp v9, v21, v52 row_newbcast:0 row_mask:0xf bank_mask:0xf
v_dot2c_f32_bf16_dpp v10, v20, v53 row_newbcast:0 row_mask:0xf bank_mask:0xf
v_dot2c_f32_bf16_dpp v11, v21, v53 row_newbcast:0 row_mask:0xf bank_mask:0xf
v_dot2c_f32_bf16_dpp v12, v20, v54 row_newbcast:0 row_mask:0xf bank_mask:0xf
v_dot2c_f32_bf16_dpp v13, v21, v54 row_newbcast:0 row_mask:0xf bank_mask:0xf
v_dot2c_f32_bf16_dpp v14, v20, v55 row_newbcast:0 row_mask:0xf bank_mask:0xf
v_dot2c_f32_bf16_dpp v15, v21, v55 row_newbcast:0 row_mask:0xf bank_mask:0xf
v_dot2c_f32_bf16_dpp v8, v22, v56 row_newbcast:0 row_mask:0xf bank_mask:0xf
v_dot2c_f32_bf16_dpp v9, v23, v56 row_newbcast:0 row_mask:0xf bank_mask:0xf
v_dot2c_f32_bf16_dpp v10, v22, v57 row_newbcast:0 row_mask:0xf bank_mask:0xf
v_dot2c_f32_bf16_dpp v11, v23, v57 row_newbcast:0 row_mask:0xf bank_mask:0xf
v_dot2c_f32_bf16_dpp v12, v22, v58 row_newbcast:0 row_mask:0xf bank_mask:0xf
v_dot2c_f32_bf16_dpp v13, v23, v58 row_newbcast:0 row_mask:0xf bank_mask:0xf
v_dot2c_f32_bf16_dpp v14, v22, v59 row_newbcast:0 row_mask:0xf bank_mask:0xf
v_dot2c_f32_bf16_dpp v15, v23, v59 row_newbcast:0 row_mask:0xf bank_mask:0xf
v_dot2c_f32_bf16_dpp v8, v20, v60 row_newbcast:1 row_mask:0xf bank_mask:0xf
v_dot2c_f32_bf16_dpp v9, v21, v60 row_newbcast:1 row_mask:0xf bank_mask:0xf
v_dot2c_f32_bf16_dpp v10, v20, v61 row_newbcast:1 row_mask:0xf bank_mask:0xf
v_dot2c_f32_bf16_dpp v11, v21, v61 row_newbcast:1 row_mask:0xf bank_mask:0xf
v_dot2c_f32_bf16_dpp v12, v20, v62 row_newbcast:1 row_mask:0xf bank_mask:0xf
v_dot2c_f32_bf16_dpp v13, v21, v62 row_newbcast:1 row_mask:0xf bank_mask:0xf
v_dot2c_f32_bf16_dpp v14, v20, v63 row_newbcast:1 row_mask:0xf bank_mask:0xf
v_dot2c_f32_bf16_dpp v15, v21, v63 row_newbcast:1 row_mask:0xf bank_mask:0xf
v_dot2c_f32_bf16_dpp v8, v22, v64 row_newbcast:1 row_mask:0xf bank_mask:0xf
v_dot2c_f32_bf16_dpp v9, v23, v64 row_newbcast:1 row_mask:0xf bank_mask:0xf
v_dot2c_f32_bf16_dpp v10, v22, v65 row_newbcast:1 row_mask:0xf bank_mask:0xf
v_dot2c_f32_bf16_dpp v11, v23, v65 row_newbcast:1 row_mask:0xf bank_mask:0xf
v_dot2c_f32_bf16_dpp v12, v22, v66 row_newbcast:1 row_mask:0xf bank_mask:0xf
v_dot2c_f32_bf16_dpp v13, v23, v66 row_newbcast:1 row_mask:0xf bank_mask:0xf
v_dot2c_f32_bf16_dpp v14, v22, v67 row_newbcast:1 row_mask:0xf bank_mask:0xf
v_dot2c_f32_bf16_dpp v15, v23, v67 row_newbcast:1 row_mask:0xf bank_mask:0xf
s_waitcnt vmcnt(24)
v_dot2c_f32_bf16_dpp v8, v20, v68 row_newbcast:2 row_mask:0xf bank_mask:0xf
v_dot2c_f32_bf16_dpp v9, v21, v68 row_newbcast:2 row_mask:0xf bank_mask:0xf
v_dot2c_f32_bf16_dpp v10, v20, v69 row_newbcast:2 row_mask:0xf bank_mask:0xf
v_dot2c_f32_bf16_dpp v11, v21, v69 row_newbcast:2 row_mask:0xf bank_mask:0xf
v_dot2c_f32_bf16_dpp v12, v20, v70 row_newbcast:2 row_mask:0xf bank_mask:0xf
v_dot2c_f32_bf16_dpp v13, v21, v70 row_newbcast:2 row_mask:0xf bank_mask:0xf
v_dot2c_f32_bf16_dpp v14, v20, v71 row_newbcast:2 row_mask:0xf bank_mask:0xf
v_dot2c_f32_bf16_dpp v15, v21, v71 row_newbcast:2 row_mask:0xf bank_mask:0xf
v_dot2c_f32_bf16_dpp v8, v22, v72 row_newbcast:2 row_mask:0xf bank_mask:0xf
v_dot2c_f32_bf16_dpp v9, v23, v72 row_newbcast:2 row_mask:0xf bank_mask:0xf
v_dot2c_f32_bf16_dpp v10, v22, v73 row_newbcast:2 row_mask:0xf bank_mask:0xf
v_dot2c_f32_bf16_dpp v11, v23, v73 row_newbcast:2 row_mask:0xf bank_mask:0xf
v_dot2c_f32_bf16_dpp v12, v22, v74 row_newbcast:2 row_mask:0xf bank_mask:0xf
v_dot2c_f32_bf16_dpp v13, v23, v74 row_newbcast:2 row_mask:0xf bank_mask:0xf
v_dot2c_f32_bf16_dpp v14, v22, v75 row_newbcast:2 row_mask:0xf bank_mask:0xf
v_dot2c_f32_bf16_dpp v15, v23, v75 row_newbcast:2 row_mask:0xf bank_mask:0xf
v_dot2c_f32_bf16_dpp v8, v20, v76 row_newbcast:3 row_mask:0xf bank_mask:0xf
v_dot2c_f32_bf16_dpp v9, v21, v76 row_newbcast:3 row_mask:0xf bank_mask:0xf
v_dot2c_f32_bf16_dpp v10, v20, v77 row_newbcast:3 row_mask:0xf bank_mask:0xf
v_dot2c_f32_bf16_dpp v11, v21, v77 row_newbcast:3 row_mask:0xf bank_mask:0xf
v_dot2c_f32_bf16_dpp v12, v20, v78 row_newbcast:3 row_mask:0xf bank_mask:0xf
v_dot2c_f32_bf16_dpp v13, v21, v78 row_newbcast:3 row_mask:0xf bank_mask:0xf
v_dot2c_f32_bf16_dpp v14, v20, v79 row_newbcast:3 row_mask:0xf bank_mask:0xf
v_dot2c_f32_bf16_dpp v15, v21, v79 row_newbcast:3 row_mask:0xf bank_mask:0xf
v_dot2c_f32_bf16_dpp v8, v22, v80 row_newbcast:3 row_mask:0xf bank_mask:0xf
v_dot2c_f32_bf16_dpp v9, v23, v80 row_newbcast:3 row_mask:0xf bank_mask:0xf
v_dot2c_f32_bf16_dpp v10, v22, v81 row_newbcast:3 row_mask:0xf bank_mask:0xf
v_dot2c_f32_bf16_dpp v11, v23, v81 row_newbcast:3 row_mask:0xf bank_mask:0xf
v_dot2c_f32_bf16_dpp v12, v22, v82 row_newbcast:3 row_mask:0xf bank_mask:0xf
v_dot2c_f32_bf16_dpp v13, v23, v82 row_newbcast:3 row_mask:0xf bank_mask:0xf
v_dot2c_f32_bf16_dpp v14, v22, v83 row_newbcast:3 row_mask:0xf bank_mask:0xf
v_dot2c_f32_bf16_dpp v15, v23, v83 row_newbcast:3 row_mask:0xf bank_mask:0xf
s_waitcnt vmcnt(20)
v_dot2c_f32_bf16_dpp v8, v20, v84 row_newbcast:4 row_mask:0xf bank_mask:0xf
v_dot2c_f32_bf16_dpp v9, v21, v84 row_newbcast:4 row_mask:0xf bank_mask:0xf
v_dot2c_f32_bf16_dpp v10, v20, v85 row_newbcast:4 row_mask:0xf bank_mask:0xf
v_dot2c_f32_bf16_dpp v11, v21, v85 row_newbcast:4 row_mask:0xf bank_mask:0xf
v_dot2c_f32_bf16_dpp v12, v20, v86 row_newbcast:4 row_mask:0xf bank_mask:0xf
v_dot2c_f32_bf16_dpp v13, v21, v86 row_newbcast:4 row_mask:0xf bank_mask:0xf
v_dot2c_f32_bf16_dpp v14, v20, v87 row_newbcast:4 row_mask:0xf bank_mask:0xf
v_dot2c_f32_bf16_dpp v15, v21, v87 row_newbcast:4 row_mask:0xf bank_mask:0xf
v_dot2c_f32_bf16_dpp v8, v22, v88 row_newbcast:4 row_mask:0xf bank_mask:0xf
v_dot2c_f32_bf16_dpp v9, v23, v88 row_newbcast:4 row_mask:0xf bank_mask:0xf
v_dot2c_f32_bf16_dpp v10, v22, v89 row_newbcast:4 row_mask:0xf bank_mask:0xf
v_dot2c_f32_bf16_dpp v11, v23, v89 row_newbcast:4 row_mask:0xf bank_mask:0xf
v_dot2c_f32_bf16_dpp v12, v22, v90 row_newbcast:4 row_mask:0xf bank_mask:0xf
v_dot2c_f32_bf16_dpp v13, v23, v90 row_newbcast:4 row_mask:0xf bank_mask:0xf
v_dot2c_f32_bf16_dpp v14, v22, v91 row_newbcast:4 row_mask:0xf bank_mask:0xf
v_dot2c_f32_bf16_dpp v15, v23, v91 row_newbcast:4 row_mask:0xf bank_mask:0xf
v_dot2c_f32_bf16_dpp v8, v20, v92 row_newbcast:5 row_mask:0xf bank_mask:0xf
v_dot2c_f32_bf16_dpp v9, v21, v92 row_newbcast:5 row_mask:0xf bank_mask:0xf
v_dot2c_f32_bf16_dpp v10, v20, v93 row_newbcast:5 row_mask:0xf bank_mask:0xf
v_dot2c_f32_bf16_dpp v11, v21, v93 row_newbcast:5 row_mask:0xf bank_mask:0xf
v_dot2c_f32_bf16_dpp v12, v20, v94 row_newbcast:5 row_mask:0xf bank_mask:0xf
v_dot2c_f32_bf16_dpp v13, v21, v94 row_newbcast:5 row_mask:0xf bank_mask:0xf
v_dot2c_f32_bf16_dpp v14, v20, v95 row_newbcast:5 row_mask:0xf bank_mask:0xf
v_dot2c_f32_bf16_dpp v15, v21, v95 row_newbcast:5 row_mask:0xf bank_mask:0xf
v_dot2c_f32_bf16_dpp v8, v22, v96 row_newbcast:5 row_mask:0xf bank_mask:0xf
v_dot2c_f32_bf16_dpp v9, v23, v96 row_newbcast:5 row_mask:0xf bank_mask:0xf
v_dot2c_f32_bf16_dpp v10, v22, v97 row_newbcast:5 row_mask:0xf bank_mask:0xf
v_dot2c_f32_bf16_dpp v11, v23, v97 row_newbcast:5 row_mask:0xf bank_mask:0xf
v_dot2c_f32_bf16_dpp v12, v22, v98 row_newbcast:5 row_mask:0xf bank_mask:0xf
v_dot2c_f32_bf16_dpp v13, v23, v98 row_newbcast:5 row_mask:0xf bank_mask:0xf
v_dot2c_f32_bf16_dpp v14, v22, v99 row_newbcast:5 row_mask:0xf bank_mask:0xf
v_dot2c_f32_bf16_dpp v15, v23, v99 row_newbcast:5 row_mask:0xf bank_mask:0xf
s_waitcnt vmcnt(16)
v_dot2c_f32_bf16_dpp v8, v20, v100 row_newbcast:6 row_mask:0xf bank_mask:0xf
v_dot2c_f32_bf16_dpp v9, v21, v100 row_newbcast:6 row_mask:0xf bank_mask:0xf
v_dot2c_f32_bf16_dpp v10, v20, v101 row_newbcast:6 row_mask:0xf bank_mask:0xf
v_dot2c_f32_bf16_dpp v11, v21, v101 row_newbcast:6 row_mask:0xf bank_mask:0xf
v_dot2c_f32_bf16_dpp v12, v20, v102 row_newbcast:6 row_mask:0xf bank_mask:0xf
v_dot2c_f32_bf16_dpp v13, v21, v102 row_newbcast:6 row_mask:0xf bank_mask:0xf
v_dot2c_f32_bf16_dpp v14, v20, v103 row_newbcast:6 row_mask:0xf bank_mask:0xf
v_dot2c_f32_bf16_dpp v15, v21, v103 row_newbcast:6 row_mask:0xf bank_mask:0xf
v_dot2c_f32_bf16_dpp v8, v22, v104 row_newbcast:6 row_mask:0xf bank_mask:0xf
v_dot2c_f32_bf16_dpp v9, v23, v104 row_newbcast:6 row_mask:0xf bank_mask:0xf
v_dot2c_f32_bf16_dpp v10, v22, v105 row_newbcast:6 row_mask:0xf bank_mask:0xf
v_dot2c_f32_bf16_dpp v11, v23, v105 row_newbcast:6 row_mask:0xf bank_mask:0xf
v_dot2c_f32_bf16_dpp v12, v22, v106 row_newbcast:6 row_mask:0xf bank_mask:0xf
v_dot2c_f32_bf16_dpp v13, v23, v106 row_newbcast:6 row_mask:0xf bank_mask:0xf
v_dot2c_f32_bf16_dpp v14, v22, v107 row_newbcast:6 row_mask:0xf bank_mask:0xf
v_dot2c_f32_bf16_dpp v15, v23, v107 row_newbcast:6 row_mask:0xf bank_mask:0xf
v_dot2c_f32_bf16_dpp v8, v20, v108 row_newbcast:7 row_mask:0xf bank_mask:0xf
v_dot2c_f32_bf16_dpp v9, v21, v108 row_newbcast:7 row_mask:0xf bank_mask:0xf
v_dot2c_f32_bf16_dpp v10, v20, v109 row_newbcast:7 row_mask:0xf bank_mask:0xf
v_dot2c_f32_bf16_dpp v11, v21, v109 row_newbcast:7 row_mask:0xf bank_mask:0xf
v_dot2c_f32_bf16_dpp v12, v20, v110 row_newbcast:7 row_mask:0xf bank_mask:0xf
v_dot2c_f32_bf16_dpp v13, v21, v110 row_newbcast:7 row_mask:0xf bank_mask:0xf
v_dot2c_f32_bf16_dpp v14, v20, v111 row_newbcast:7 row_mask:0xf bank_mask:0xf
v_dot2c_f32_bf16_dpp v15, v21, v111 row_newbcast:7 row_mask:0xf bank_mask:0xf
v_dot2c_f32_bf16_dpp v8, v22, v112 row_newbcast:7 row_mask:0xf bank_mask:0xf
v_dot2c_f32_bf16_dpp v9, v23, v112 row_newbcast:7 row_mask:0xf bank_mask:0xf
v_dot2c_f32_bf16_dpp v10, v22, v113 row_newbcast:7 row_mask:0xf bank_mask:0xf
v_dot2c_f32_bf16_dpp v11, v23, v113 row_newbcast:7 row_mask:0xf bank_mask:0xf
v_dot2c_f32_bf16_dpp v12, v22, v114 row_newbcast:7 row_mask:0xf bank_mask:0xf
v_dot2c_f32_bf16_dpp v13, v23, v114 row_newbcast:7 row_mask:0xf bank_mask:0xf
v_dot2c_f32_bf16_dpp v14, v22, v115 row_newbcast:7 row_mask:0xf bank_mask:0xf
v_dot2c_f32_bf16_dpp v15, v23, v115 row_newbcast:7 row_mask:0xf bank_mask:0xf
s_waitcnt vmcnt(12)
v_dot2c_f32_bf16_dpp v8, v20, v116 row_newbcast:8 row_mask:0xf bank_mask:0xf
v_dot2c_f32_bf16_dpp v9, v21, v116 row_newbcast:8 row_mask:0xf bank_mask:0xf
v_dot2c_f32_bf16_dpp v10, v20, v117 row_newbcast:8 row_mask:0xf bank_mask:0xf
v_dot2c_f32_bf16_dpp v11, v21, v117 row_newbcast:8 row_mask:0xf bank_mask:0xf
v_dot2c_f32_bf16_dpp v12, v20, v118 row_newbcast:8 row_mask:0xf bank_mask:0xf
v_dot2c_f32_bf16_dpp v13, v21, v118 row_newbcast:8 row_mask:0xf bank_mask:0xf
v_dot2c_f32_bf16_dpp v14, v20, v119 row_newbcast:8 row_mask:0xf bank_mask:0xf
v_dot2c_f32_bf16_dpp v15, v21, v119 row_newbcast:8 row_mask:0xf bank_mask:0xf
v_dot2c_f32_bf16_dpp v8, v22, v120 row_newbcast:8 row_mask:0xf bank_mask:0xf
v_dot2c_f32_bf16_dpp v9, v23, v120 row_newbcast:8 row_mask:0xf bank_mask:0xf
v_dot2c_f32_bf16_dpp v10, v22, v121 row_newbcast:8 row_mask:0xf bank_mask:0xf
v_dot2c_f32_bf16_dpp v11, v23, v121 row_newbcast:8 row_mask:0xf bank_mask:0xf
v_dot2c_f32_bf16_dpp v12, v22, v122 row_newbcast:8 row_mask:0xf bank_mask:0xf
v_dot2c_f32_bf16_dpp v13, v23, v122 row_newbcast:8 row_mask:0xf bank_mask:0xf
v_dot2c_f32_bf16_dpp v14, v22, v123 row_newbcast:8 row_mask:0xf bank_mask:0xf
v_dot2c_f32_bf16_dpp v15, v23, v123 row_newbcast:8 row_mask:0xf bank_mask:0xf
v_dot2c_f32_bf16_dpp v8, v20, v124 row_newbcast:9 row_mask:0xf bank_mask:0xf
v_dot2c_f32_bf16_dpp v9, v21, v124 row_newbcast:9 row_mask:0xf bank_mask:0xf
v_dot2c_f32_bf16_dpp v10, v20, v125 row_newbcast:9 row_mask:0xf bank_mask:0xf
v_dot2c_f32_bf16_dpp v11, v21, v125 row_newbcast:9 row_mask:0xf bank_mask:0xf
v_dot2c_f32_bf16_dpp v12, v20, v126 row_newbcast:9 row_mask:0xf bank_mask:0xf
v_dot2c_f32_bf16_dpp v13, v21, v126 row_newbcast:9 row_mask:0xf bank_mask:0xf
v_dot2c_f32_bf16_dpp v14, v20, v127 row_newbcast:9 row_mask:0xf bank_mask:0xf
v_dot2c_f32_bf16_dpp v15, v21, v127 row_newbcast:9 row_mask:0xf bank_mask:0xf
v_dot2c_f32_bf16_dpp v8, v22, v128 row_newbcast:9 row_mask:0xf bank_mask:0xf
v_dot2c_f32_bf16_dpp v9, v23, v128 row_newbcast:9 row_mask:0xf bank_mask:0xf
v_dot2c_f32_bf16_dpp v10, v22, v129 row_newbcast:9 row_mask:0xf bank_mask:0xf
v_dot2c_f32_bf16_dpp v11, v23, v129 row_newbcast:9 row_mask:0xf bank_mask:0xf
v_dot2c_f32_bf16_dpp v12, v22, v130 row_newbcast:9 row_mask:0xf bank_mask:0xf
v_dot2c_f32_bf16_dpp v13, v23, v130 row_newbcast:9 row_mask:0xf bank_mask:0xf
v_dot2c_f32_bf16_dpp v14, v22, v131 row_newbcast:9 row_mask:0xf bank_mask:0xf
v_dot2c_f32_bf16_dpp v15, v23, v131 row_newbcast:9 row_mask:0xf bank_mask:0xf
s_waitcnt vmcnt(8)
v_dot2c_f32_bf16_dpp v8, v20, v132 row_newbcast:10 row_mask:0xf bank_mask:0xf
v_dot2c_f32_bf16_dpp v9, v21, v132 row_newbcast:10 row_mask:0xf bank_mask:0xf
v_dot2c_f32_bf16_dpp v10, v20, v133 row_newbcast:10 row_mask:0xf bank_mask:0xf
v_dot2c_f32_bf16_dpp v11, v21, v133 row_newbcast:10 row_mask:0xf bank_mask:0xf
v_dot2c_f32_bf16_dpp v12, v20, v134 row_newbcast:10 row_mask:0xf bank_mask:0xf
v_dot2c_f32_bf16_dpp v13, v21, v134 row_newbcast:10 row_mask:0xf bank_mask:0xf
v_dot2c_f32_bf16_dpp v14, v20, v135 row_newbcast:10 row_mask:0xf bank_mask:0xf
v_dot2c_f32_bf16_dpp v15, v21, v135 row_newbcast:10 row_mask:0xf bank_mask:0xf
v_dot2c_f32_bf16_dpp v8, v22, v136 row_newbcast:10 row_mask:0xf bank_mask:0xf
v_dot2c_f32_bf16_dpp v9, v23, v136 row_newbcast:10 row_mask:0xf bank_mask:0xf
v_dot2c_f32_bf16_dpp v10, v22, v137 row_newbcast:10 row_mask:0xf bank_mask:0xf
v_dot2c_f32_bf16_dpp v11, v23, v137 row_newbcast:10 row_mask:0xf bank_mask:0xf
v_dot2c_f32_bf16_dpp v12, v22, v138 row_newbcast:10 row_mask:0xf bank_mask:0xf
v_dot2c_f32_bf16_dpp v13, v23, v138 row_newbcast:10 row_mask:0xf bank_mask:0xf
v_dot2c_f32_bf16_dpp v14, v22, v139 row_newbcast:10 row_mask:0xf bank_mask:0xf
v_dot2c_f32_bf16_dpp v15, v23, v139 row_newbcast:10 row_mask:0xf bank_mask:0xf
v_dot2c_f32_bf16_dpp v8, v20, v140 row_newbcast:11 row_mask:0xf bank_mask:0xf
v_dot2c_f32_bf16_dpp v9, v21, v140 row_newbcast:11 row_mask:0xf bank_mask:0xf
v_dot2c_f32_bf16_dpp v10, v20, v141 row_newbcast:11 row_mask:0xf bank_mask:0xf
v_dot2c_f32_bf16_dpp v11, v21, v141 row_newbcast:11 row_mask:0xf bank_mask:0xf
v_dot2c_f32_bf16_dpp v12, v20, v142 row_newbcast:11 row_mask:0xf bank_mask:0xf
v_dot2c_f32_bf16_dpp v13, v21, v142 row_newbcast:11 row_mask:0xf bank_mask:0xf
v_dot2c_f32_bf16_dpp v14, v20, v143 row_newbcast:11 row_mask:0xf bank_mask:0xf
v_dot2c_f32_bf16_dpp v15, v21, v143 row_newbcast:11 row_mask:0xf bank_mask:0xf
v_dot2c_f32_bf16_dpp v8, v22, v144 row_newbcast:11 row_mask:0xf bank_mask:0xf
v_dot2c_f32_bf16_dpp v9, v23, v144 row_newbcast:11 row_mask:0xf bank_mask:0xf
v_dot2c_f32_bf16_dpp v10, v22, v145 row_newbcast:11 row_mask:0xf bank_mask:0xf
v_dot2c_f32_bf16_dpp v11, v23, v145 row_newbcast:11 row_mask:0xf bank_mask:0xf
v_dot2c_f32_bf16_dpp v12, v22, v146 row_newbcast:11 row_mask:0xf bank_mask:0xf
v_dot2c_f32_bf16_dpp v13, v23, v146 row_newbcast:11 row_mask:0xf bank_mask:0xf
v_dot2c_f32_bf16_dpp v14, v22, v147 row_newbcast:11 row_mask:0xf bank_mask:0xf
v_dot2c_f32_bf16_dpp v15, v23, v147 row_newbcast:11 row_mask:0xf bank_mask:0xf
s_waitcnt vmcnt(4)
v_dot2c_f32_bf16_dpp v8, v20, v148 row_newbcast:12 row_mask:0xf bank_mask:0xf
v_dot2c_f32_bf16_dpp v9, v21, v148 row_newbcast:12 row_mask:0xf bank_mask:0xf
v_dot2c_f32_bf16_dpp v10, v20, v149 row_newbcast:12 row_mask:0xf bank_mask:0xf
v_dot2c_f32_bf16_dpp v11, v21, v149 row_newbcast:12 row_mask:0xf bank_mask:0xf
v_dot2c_f32_bf16_dpp v12, v20, v150 row_newbcast:12 row_mask:0xf bank_mask:0xf
v_dot2c_f32_bf16_dpp v13, v21, v150 row_newbcast:12 row_mask:0xf bank_mask:0xf
v_dot2c_f32_bf16_dpp v14, v20, v151 row_newbcast:12 row_mask:0xf bank_mask:0xf
v_dot2c_f32_bf16_dpp v15, v21, v151 row_newbcast:12 row_mask:0xf bank_mask:0xf
v_dot2c_f32_bf16_dpp v8, v22, v152 row_newbcast:12 row_mask:0xf bank_mask:0xf
v_dot2c_f32_bf16_dpp v9, v23, v152 row_newbcast:12 row_mask:0xf bank_mask:0xf
v_dot2c_f32_bf16_dpp v10, v22, v153 row_newbcast:12 row_mask:0xf bank_mask:0xf
v_dot2c_f32_bf16_dpp v11, v23, v153 row_newbcast:12 row_mask:0xf bank_mask:0xf
v_dot2c_f32_bf16_dpp v12, v22, v154 row_newbcast:12 row_mask:0xf bank_mask:0xf
v_dot2c_f32_bf16_dpp v13, v23, v154 row_newbcast:12 row_mask:0xf bank_mask:0xf
v_dot2c_f32_bf16_dpp v14, v22, v155 row_newbcast:12 row_mask:0xf bank_mask:0xf
v_dot2c_f32_bf16_dpp v15, v23, v155 row_newbcast:12 row_mask:0xf bank_mask:0xf
v_dot2c_f32_bf16_dpp v8, v20, v156 row_newbcast:13 row_mask:0xf bank_mask:0xf
v_dot2c_f32_bf16_dpp v9, v21, v156 row_newbcast:13 row_mask:0xf bank_mask:0xf
v_dot2c_f32_bf16_dpp v10, v20, v157 row_newbcast:13 row_mask:0xf bank_mask:0xf
v_dot2c_f32_bf16_dpp v11, v21, v157 row_newbcast:13 row_mask:0xf bank_mask:0xf
v_dot2c_f32_bf16_dpp v12, v20, v158 row_newbcast:13 row_mask:0xf bank_mask:0xf
v_dot2c_f32_bf16_dpp v13, v21, v158 row_newbcast:13 row_mask:0xf bank_mask:0xf
v_dot2c_f32_bf16_dpp v14, v20, v159 row_newbcast:13 row_mask:0xf bank_mask:0xf
v_dot2c_f32_bf16_dpp v15, v21, v159 row_newbcast:13 row_mask:0xf bank_mask:0xf
v_dot2c_f32_bf16_dpp v8, v22, v160 row_newbcast:13 row_mask:0xf bank_mask:0xf
v_dot2c_f32_bf16_dpp v9, v23, v160 row_newbcast:13 row_mask:0xf bank_mask:0xf
v_dot2c_f32_bf16_dpp v10, v22, v161 row_newbcast:13 row_mask:0xf bank_mask:0xf
v_dot2c_f32_bf16_dpp v11, v23, v161 row_newbcast:13 row_mask:0xf bank_mask:0xf
v_dot2c_f32_bf16_dpp v12, v22, v162 row_newbcast:13 row_mask:0xf bank_mask:0xf
v_dot2c_f32_bf16_dpp v13, v23, v162 row_newbcast:13 row_mask:0xf bank_mask:0xf
v_dot2c_f32_bf16_dpp v14, v22, v163 row_newbcast:13 row_mask:0xf bank_mask:0xf
v_dot2c_f32_bf16_dpp v15, v23, v163 row_newbcast:13 row_mask:0xf bank_mask:0xf
s_waitcnt vmcnt(0)
v_dot2c_f32_bf16_dpp v8, v20, v164 row_newbcast:14 row_mask:0xf bank_mask:0xf
v_dot2c_f32_bf16_dpp v9, v21, v164 row_newbcast:14 row_mask:0xf bank_mask:0xf
v_dot2c_f32_bf16_dpp v10, v20, v165 row_newbcast:14 row_mask:0xf bank_mask:0xf
v_dot2c_f32_bf16_dpp v11, v21, v165 row_newbcast:14 row_mask:0xf bank_mask:0xf
v_dot2c_f32_bf16_dpp v12, v20, v166 row_newbcast:14 row_mask:0xf bank_mask:0xf
v_dot2c_f32_bf16_dpp v13, v21, v166 row_newbcast:14 row_mask:0xf bank_mask:0xf
v_dot2c_f32_bf16_dpp v14, v20, v167 row_newbcast:14 row_mask:0xf bank_mask:0xf
v_dot2c_f32_bf16_dpp v15, v21, v167 row_newbcast:14 row_mask:0xf bank_mask:0xf
v_dot2c_f32_bf16_dpp v8, v22, v168 row_newbcast:14 row_mask:0xf bank_mask:0xf
v_dot2c_f32_bf16_dpp v9, v23, v168 row_newbcast:14 row_mask:0xf bank_mask:0xf
v_dot2c_f32_bf16_dpp v10, v22, v169 row_newbcast:14 row_mask:0xf bank_mask:0xf
v_dot2c_f32_bf16_dpp v11, v23, v169 row_newbcast:14 row_mask:0xf bank_mask:0xf
v_dot2c_f32_bf16_dpp v12, v22, v170 row_newbcast:14 row_mask:0xf bank_mask:0xf
v_dot2c_f32_bf16_dpp v13, v23, v170 row_newbcast:14 row_mask:0xf bank_mask:0xf
v_dot2c_f32_bf16_dpp v14, v22, v171 row_newbcast:14 row_mask:0xf bank_mask:0xf
v_dot2c_f32_bf16_dpp v15, v23, v171 row_newbcast:14 row_mask:0xf bank_mask:0xf
v_dot2c_f32_bf16_dpp v8, v20, v172 row_newbcast:15 row_mask:0xf bank_mask:0xf
v_dot2c_f32_bf16_dpp v9, v21, v172 row_newbcast:15 row_mask:0xf bank_mask:0xf
v_dot2c_f32_bf16_dpp v10, v20, v173 row_newbcast:15 row_mask:0xf bank_mask:0xf
v_dot2c_f32_bf16_dpp v11, v21, v173 row_newbcast:15 row_mask:0xf bank_mask:0xf
v_dot2c_f32_bf16_dpp v12, v20, v174 row_newbcast:15 row_mask:0xf bank_mask:0xf
v_dot2c_f32_bf16_dpp v13, v21, v174 row_newbcast:15 row_mask:0xf bank_mask:0xf
v_dot2c_f32_bf16_dpp v14, v20, v175 row_newbcast:15 row_mask:0xf bank_mask:0xf
v_dot2c_f32_bf16_dpp v15, v21, v175 row_newbcast:15 row_mask:0xf bank_mask:0xf
v_dot2c_f32_bf16_dpp v8, v22, v176 row_newbcast:15 row_mask:0xf bank_mask:0xf
v_dot2c_f32_bf16_dpp v9, v23, v176 row_newbcast:15 row_mask:0xf bank_mask:0xf
v_dot2c_f32_bf16_dpp v10, v22, v177 row_newbcast:15 row_mask:0xf bank_mask:0xf
v_dot2c_f32_bf16_dpp v11, v23, v177 row_newbcast:15 row_mask:0xf bank_mask:0xf
v_dot2c_f32_bf16_dpp v12, v22, v178 row_newbcast:15 row_mask:0xf bank_mask:0xf
v_dot2c_f32_bf16_dpp v13, v23, v178 row_newbcast:15 row_mask:0xf bank_mask:0xf
v_dot2c_f32_bf16_dpp v14, v22, v179 row_newbcast:15 row_mask:0xf bank_mask:0xf
v_dot2c_f32_bf16_dpp v15, v23, v179 row_newbcast:15 row_mask:0xf bank_mask:0xf
s_nop 2
ds_write_b128 v34, v[8:11] offset:8704
ds_write_b128 v34, v[12:15] offset:9792
s_add_u32 s48, s12, s71
s_addc_u32 s49, s13, 0
s_lshl_b32 s72, s74, 11
buffer_load_dwordx4 v[52:55], v42, s[48:51], s72 offen offset:0
buffer_load_dwordx4 v[56:59], v42, s[48:51], s72 offen offset:1024
buffer_load_dwordx4 v[60:63], v42, s[48:51], s72 offen offset:2048
buffer_load_dwordx4 v[64:67], v42, s[48:51], s72 offen offset:3072
s_add_u32 s72, s72, 4096
s_and_b32 s72, s72, 0x7fff
buffer_load_dwordx4 v[68:71], v42, s[48:51], s72 offen offset:0
buffer_load_dwordx4 v[72:75], v42, s[48:51], s72 offen offset:1024
buffer_load_dwordx4 v[76:79], v42, s[48:51], s72 offen offset:2048
buffer_load_dwordx4 v[80:83], v42, s[48:51], s72 offen offset:3072
s_add_u32 s72, s72, 4096
s_and_b32 s72, s72, 0x7fff
buffer_load_dwordx4 v[84:87], v42, s[48:51], s72 offen offset:0
buffer_load_dwordx4 v[88:91], v42, s[48:51], s72 offen offset:1024
buffer_load_dwordx4 v[92:95], v42, s[48:51], s72 offen offset:2048
buffer_load_dwordx4 v[96:99], v42, s[48:51], s72 offen offset:3072
s_add_u32 s72, s72, 4096
s_and_b32 s72, s72, 0x7fff
buffer_load_dwordx4 v[100:103], v42, s[48:51], s72 offen offset:0
buffer_load_dwordx4 v[104:107], v42, s[48:51], s72 offen offset:1024
buffer_load_dwordx4 v[108:111], v42, s[48:51], s72 offen offset:2048
buffer_load_dwordx4 v[112:115], v42, s[48:51], s72 offen offset:3072
s_add_u32 s72, s72, 4096
s_and_b32 s72, s72, 0x7fff
buffer_load_dwordx4 v[116:119], v42, s[48:51], s72 offen offset:0
buffer_load_dwordx4 v[120:123], v42, s[48:51], s72 offen offset:1024
buffer_load_dwordx4 v[124:127], v42, s[48:51], s72 offen offset:2048
buffer_load_dwordx4 v[128:131], v42, s[48:51], s72 offen offset:3072
s_add_u32 s72, s72, 4096
s_and_b32 s72, s72, 0x7fff
buffer_load_dwordx4 v[132:135], v42, s[48:51], s72 offen offset:0
buffer_load_dwordx4 v[136:139], v42, s[48:51], s72 offen offset:1024
buffer_load_dwordx4 v[140:143], v42, s[48:51], s72 offen offset:2048
buffer_load_dwordx4 v[144:147], v42, s[48:51], s72 offen offset:3072
s_add_u32 s72, s72, 4096
s_and_b32 s72, s72, 0x7fff
buffer_load_dwordx4 v[148:151], v42, s[48:51], s72 offen offset:0
buffer_load_dwordx4 v[152:155], v42, s[48:51], s72 offen offset:1024
buffer_load_dwordx4 v[156:159], v42, s[48:51], s72 offen offset:2048
buffer_load_dwordx4 v[160:163], v42, s[48:51], s72 offen offset:3072
s_add_u32 s72, s72, 4096
s_and_b32 s72, s72, 0x7fff
buffer_load_dwordx4 v[164:167], v42, s[48:51], s72 offen offset:0
buffer_load_dwordx4 v[168:171], v42, s[48:51], s72 offen offset:1024
buffer_load_dwordx4 v[172:175], v42, s[48:51], s72 offen offset:2048
buffer_load_dwordx4 v[176:179], v42, s[48:51], s72 offen offset:3072
s_add_u32 s72, s72, 4096
s_and_b32 s72, s72, 0x7fff
s_waitcnt vmcnt(30)
v_perm_b32 v48, v56, v52, s64
v_perm_b32 v56, v56, v52, s65
v_perm_b32 v49, v57, v53, s64
v_perm_b32 v57, v57, v53, s65
v_perm_b32 v50, v58, v54, s64
v_perm_b32 v58, v58, v54, s65
v_perm_b32 v51, v59, v55, s64
v_perm_b32 v59, v59, v55, s65
s_waitcnt vmcnt(28)
v_perm_b32 v52, v64, v60, s64
v_perm_b32 v64, v64, v60, s65
v_perm_b32 v53, v65, v61, s64
v_perm_b32 v65, v65, v61, s65
v_perm_b32 v54, v66, v62, s64
v_perm_b32 v66, v66, v62, s65
v_perm_b32 v55, v67, v63, s64
v_perm_b32 v67, v67, v63, s65
s_waitcnt vmcnt(26)
v_perm_b32 v60, v72, v68, s64
v_perm_b32 v72, v72, v68, s65
v_perm_b32 v61, v73, v69, s64
v_perm_b32 v73, v73, v69, s65
v_perm_b32 v62, v74, v70, s64
v_perm_b32 v74, v74, v70, s65
v_perm_b32 v63, v75, v71, s64
v_perm_b32 v75, v75, v71, s65
s_waitcnt vmcnt(24)
v_perm_b32 v68, v80, v76, s64
v_perm_b32 v80, v80, v76, s65
v_perm_b32 v69, v81, v77, s64
v_perm_b32 v81, v81, v77, s65
v_perm_b32 v70, v82, v78, s64
v_perm_b32 v82, v82, v78, s65
v_perm_b32 v71, v83, v79, s64
v_perm_b32 v83, v83, v79, s65
s_waitcnt vmcnt(22)
v_perm_b32 v76, v88, v84, s64
v_perm_b32 v88, v88, v84, s65
v_perm_b32 v77, v89, v85, s64
v_perm_b32 v89, v89, v85, s65
v_perm_b32 v78, v90, v86, s64
v_perm_b32 v90, v90, v86, s65
v_perm_b32 v79, v91, v87, s64
v_perm_b32 v91, v91, v87, s65
s_waitcnt vmcnt(20)
v_perm_b32 v84, v96, v92, s64
v_perm_b32 v96, v96, v92, s65
v_perm_b32 v85, v97, v93, s64
v_perm_b32 v97, v97, v93, s65
v_perm_b32 v86, v98, v94, s64
v_perm_b32 v98, v98, v94, s65
v_perm_b32 v87, v99, v95, s64
v_perm_b32 v99, v99, v95, s65
s_waitcnt vmcnt(18)
v_perm_b32 v92, v104, v100, s64
v_perm_b32 v104, v104, v100, s65
v_perm_b32 v93, v105, v101, s64
v_perm_b32 v105, v105, v101, s65
v_perm_b32 v94, v106, v102, s64
v_perm_b32 v106, v106, v102, s65
v_perm_b32 v95, v107, v103, s64
v_perm_b32 v107, v107, v103, s65
s_waitcnt vmcnt(16)
v_perm_b32 v100, v112, v108, s64
v_perm_b32 v112, v112, v108, s65
v_perm_b32 v101, v113, v109, s64
v_perm_b32 v113, v113, v109, s65
v_perm_b32 v102, v114, v110, s64
v_perm_b32 v114, v114, v110, s65
v_perm_b32 v103, v115, v111, s64
v_perm_b32 v115, v115, v111, s65
s_waitcnt vmcnt(14)
v_perm_b32 v108, v120, v116, s64
v_perm_b32 v120, v120, v116, s65
v_perm_b32 v109, v121, v117, s64
v_perm_b32 v121, v121, v117, s65
v_perm_b32 v110, v122, v118, s64
v_perm_b32 v122, v122, v118, s65
v_perm_b32 v111, v123, v119, s64
v_perm_b32 v123, v123, v119, s65
s_waitcnt vmcnt(12)
v_perm_b32 v116, v128, v124, s64
v_perm_b32 v128, v128, v124, s65
v_perm_b32 v117, v129, v125, s64
v_perm_b32 v129, v129, v125, s65
v_perm_b32 v118, v130, v126, s64
v_perm_b32 v130, v130, v126, s65
v_perm_b32 v119, v131, v127, s64
v_perm_b32 v131, v131, v127, s65
s_waitcnt vmcnt(10)
v_perm_b32 v124, v136, v132, s64
v_perm_b32 v136, v136, v132, s65
v_perm_b32 v125, v137, v133, s64
v_perm_b32 v137, v137, v133, s65
v_perm_b32 v126, v138, v134, s64
v_perm_b32 v138, v138, v134, s65
v_perm_b32 v127, v139, v135, s64
v_perm_b32 v139, v139, v135, s65
s_waitcnt vmcnt(8)
v_perm_b32 v132, v144, v140, s64
v_perm_b32 v144, v144, v140, s65
v_perm_b32 v133, v145, v141, s64
v_perm_b32 v145, v145, v141, s65
v_perm_b32 v134, v146, v142, s64
v_perm_b32 v146, v146, v142, s65
v_perm_b32 v135, v147, v143, s64
v_perm_b32 v147, v147, v143, s65
s_waitcnt vmcnt(6)
v_perm_b32 v140, v152, v148, s64
v_perm_b32 v152, v152, v148, s65
v_perm_b32 v141, v153, v149, s64
v_perm_b32 v153, v153, v149, s65
v_perm_b32 v142, v154, v150, s64
v_perm_b32 v154, v154, v150, s65
v_perm_b32 v143, v155, v151, s64
v_perm_b32 v155, v155, v151, s65
s_waitcnt vmcnt(4)
v_perm_b32 v148, v160, v156, s64
v_perm_b32 v160, v160, v156, s65
v_perm_b32 v149, v161, v157, s64
v_perm_b32 v161, v161, v157, s65
v_perm_b32 v150, v162, v158, s64
v_perm_b32 v162, v162, v158, s65
v_perm_b32 v151, v163, v159, s64
v_perm_b32 v163, v163, v159, s65
s_waitcnt vmcnt(2)
v_perm_b32 v156, v168, v164, s64
v_perm_b32 v168, v168, v164, s65
v_perm_b32 v157, v169, v165, s64
v_perm_b32 v169, v169, v165, s65
v_perm_b32 v158, v170, v166, s64
v_perm_b32 v170, v170, v166, s65
v_perm_b32 v159, v171, v167, s64
v_perm_b32 v171, v171, v167, s65
s_waitcnt vmcnt(0)
v_perm_b32 v164, v176, v172, s64
v_perm_b32 v176, v176, v172, s65
v_perm_b32 v165, v177, v173, s64
v_perm_b32 v177, v177, v173, s65
v_perm_b32 v166, v178, v174, s64
v_perm_b32 v178, v178, v174, s65
v_perm_b32 v167, v179, v175, s64
v_perm_b32 v179, v179, v175, s65
v_mov_b32 v8, 0
v_mov_b32 v9, 0
v_mov_b32 v10, 0
v_mov_b32 v11, 0
v_mov_b32 v12, 0
v_mov_b32 v13, 0
v_mov_b32 v14, 0
v_mov_b32 v15, 0
s_waitcnt lgkmcnt(0)
s_barrier
ds_read_b64 v[16:17], v33 offset:8704
ds_read_b64 v[18:19], v33 offset:8960
ds_read_b64 v[20:21], v33 offset:9216
ds_read_b64 v[22:23], v33 offset:9472
s_waitcnt lgkmcnt(2)
v_add_f32 v16, v16, v18
v_add_f32 v17, v17, v19
s_waitcnt lgkmcnt(0)
v_add_f32 v20, v20, v22
v_add_f32 v21, v21, v23
v_add_f32 v16, v16, v20
v_add_f32 v17, v17, v21
v_mov_b32 v18, v16
v_mov_b32 v19, v17
s_nop 0
v_permlane16_swap_b32 v16, v18
v_permlane16_swap_b32 v17, v19
s_nop 0
v_add_f32 v16, v16, v18
v_add_f32 v17, v17, v19
v_mov_b32 v18, v16
v_mov_b32 v19, v17
s_nop 0
v_permlane32_swap_b32 v16, v18
v_permlane32_swap_b32 v17, v19
s_nop 0
v_add_f32 v16, v16, v18
v_add_f32 v17, v17, v19
v_cvt_pk_bf16_f32 v24, v16, v17
ds_write_b32 v43, v24 offset:17664
s_barrier
s_cmp_lg_u32 s62, 0
s_cbranch_scc1 L_nostata
ds_read_b32 v24, v47 offset:17920
ds_read_b32 v25, v47 offset:17984
s_waitcnt lgkmcnt(0)
s_nop 0
v_max_f32_dpp v24, v24, v24 row_ror:8 row_mask:0xf bank_mask:0xf
v_add_f32_dpp v25, v25, v25 row_ror:8 row_mask:0xf bank_mask:0xf
s_nop 0
v_max_f32_dpp v24, v24, v24 row_ror:4 row_mask:0xf bank_mask:0xf
v_add_f32_dpp v25, v25, v25 row_ror:4 row_mask:0xf bank_mask:0xf
s_nop 0
v_max_f32_dpp v24, v24, v24 row_ror:2 row_mask:0xf bank_mask:0xf
v_add_f32_dpp v25, v25, v25 row_ror:2 row_mask:0xf bank_mask:0xf
s_nop 0
v_max_f32_dpp v24, v24, v24 row_ror:1 row_mask:0xf bank_mask:0xf
v_add_f32_dpp v25, v25, v25 row_ror:1 row_mask:0xf bank_mask:0xf
v_mul_f32 v24, s63, v24
s_lshl_b32 s72, s69, 3
s_add_u32 s72, s72, 1048576
s_mov_b64 exec, 1
buffer_store_dwordx2 v[24:25], v38, s[56:59], s72 offen
s_mov_b64 exec, -1
L_nostata:
s_lshl_b32 s76, s69, 11
s_waitcnt lgkmcnt(0)
s_barrier
ds_read_b64 v[16:17], v33 offset:0
ds_read_b64 v[18:19], v33 offset:256
ds_read_b64 v[20:21], v33 offset:512
ds_read_b64 v[22:23], v33 offset:768
s_waitcnt lgkmcnt(2)
v_add_f32 v16, v16, v18
v_add_f32 v17, v17, v19
s_waitcnt lgkmcnt(0)
v_add_f32 v20, v20, v22
v_add_f32 v21, v21, v23
v_add_f32 v16, v16, v20
v_add_f32 v17, v17, v21
v_mov_b32 v18, v16
v_mov_b32 v19, v17
s_nop 0
v_permlane16_swap_b32 v16, v18
v_permlane16_swap_b32 v17, v19
s_nop 0
v_add_f32 v16, v16, v18
v_add_f32 v17, v17, v19
v_mov_b32 v18, v16
v_mov_b32 v19, v17
s_nop 0
v_permlane32_swap_b32 v16, v18
v_permlane32_swap_b32 v17, v19
s_nop 0
v_add_f32 v16, v16, v18
v_add_f32 v17, v17, v19
v_cvt_pk_bf16_f32 v24, v16, v17
s_nop 1
v_dot2c_f32_bf16_dpp v8, v24, v48 row_newbcast:0 row_mask:0xf bank_mask:0xf
v_dot2c_f32_bf16_dpp v9, v24, v56 row_newbcast:0 row_mask:0xf bank_mask:0xf
v_dot2c_f32_bf16_dpp v10, v24, v49 row_newbcast:0 row_mask:0xf bank_mask:0xf
v_dot2c_f32_bf16_dpp v11, v24, v57 row_newbcast:0 row_mask:0xf bank_mask:0xf
v_dot2c_f32_bf16_dpp v12, v24, v50 row_newbcast:0 row_mask:0xf bank_mask:0xf
v_dot2c_f32_bf16_dpp v13, v24, v58 row_newbcast:0 row_mask:0xf bank_mask:0xf
v_dot2c_f32_bf16_dpp v14, v24, v51 row_newbcast:0 row_mask:0xf bank_mask:0xf
v_dot2c_f32_bf16_dpp v15, v24, v59 row_newbcast:0 row_mask:0xf bank_mask:0xf
v_dot2c_f32_bf16_dpp v8, v24, v52 row_newbcast:1 row_mask:0xf bank_mask:0xf
v_dot2c_f32_bf16_dpp v9, v24, v64 row_newbcast:1 row_mask:0xf bank_mask:0xf
v_dot2c_f32_bf16_dpp v10, v24, v53 row_newbcast:1 row_mask:0xf bank_mask:0xf
v_dot2c_f32_bf16_dpp v11, v24, v65 row_newbcast:1 row_mask:0xf bank_mask:0xf
v_dot2c_f32_bf16_dpp v12, v24, v54 row_newbcast:1 row_mask:0xf bank_mask:0xf
v_dot2c_f32_bf16_dpp v13, v24, v66 row_newbcast:1 row_mask:0xf bank_mask:0xf
v_dot2c_f32_bf16_dpp v14, v24, v55 row_newbcast:1 row_mask:0xf bank_mask:0xf
v_dot2c_f32_bf16_dpp v15, v24, v67 row_newbcast:1 row_mask:0xf bank_mask:0xf
v_dot2c_f32_bf16_dpp v8, v24, v60 row_newbcast:2 row_mask:0xf bank_mask:0xf
v_dot2c_f32_bf16_dpp v9, v24, v72 row_newbcast:2 row_mask:0xf bank_mask:0xf
v_dot2c_f32_bf16_dpp v10, v24, v61 row_newbcast:2 row_mask:0xf bank_mask:0xf
v_dot2c_f32_bf16_dpp v11, v24, v73 row_newbcast:2 row_mask:0xf bank_mask:0xf
v_dot2c_f32_bf16_dpp v12, v24, v62 row_newbcast:2 row_mask:0xf bank_mask:0xf
v_dot2c_f32_bf16_dpp v13, v24, v74 row_newbcast:2 row_mask:0xf bank_mask:0xf
v_dot2c_f32_bf16_dpp v14, v24, v63 row_newbcast:2 row_mask:0xf bank_mask:0xf
v_dot2c_f32_bf16_dpp v15, v24, v75 row_newbcast:2 row_mask:0xf bank_mask:0xf
v_dot2c_f32_bf16_dpp v8, v24, v68 row_newbcast:3 row_mask:0xf bank_mask:0xf
v_dot2c_f32_bf16_dpp v9, v24, v80 row_newbcast:3 row_mask:0xf bank_mask:0xf
v_dot2c_f32_bf16_dpp v10, v24, v69 row_newbcast:3 row_mask:0xf bank_mask:0xf
v_dot2c_f32_bf16_dpp v11, v24, v81 row_newbcast:3 row_mask:0xf bank_mask:0xf
v_dot2c_f32_bf16_dpp v12, v24, v70 row_newbcast:3 row_mask:0xf bank_mask:0xf
v_dot2c_f32_bf16_dpp v13, v24, v82 row_newbcast:3 row_mask:0xf bank_mask:0xf
v_dot2c_f32_bf16_dpp v14, v24, v71 row_newbcast:3 row_mask:0xf bank_mask:0xf
v_dot2c_f32_bf16_dpp v15, v24, v83 row_newbcast:3 row_mask:0xf bank_mask:0xf
v_dot2c_f32_bf16_dpp v8, v24, v76 row_newbcast:4 row_mask:0xf bank_mask:0xf
v_dot2c_f32_bf16_dpp v9, v24, v88 row_newbcast:4 row_mask:0xf bank_mask:0xf
v_dot2c_f32_bf16_dpp v10, v24, v77 row_newbcast:4 row_mask:0xf bank_mask:0xf
v_dot2c_f32_bf16_dpp v11, v24, v89 row_newbcast:4 row_mask:0xf bank_mask:0xf
v_dot2c_f32_bf16_dpp v12, v24, v78 row_newbcast:4 row_mask:0xf bank_mask:0xf
v_dot2c_f32_bf16_dpp v13, v24, v90 row_newbcast:4 row_mask:0xf bank_mask:0xf
v_dot2c_f32_bf16_dpp v14, v24, v79 row_newbcast:4 row_mask:0xf bank_mask:0xf
v_dot2c_f32_bf16_dpp v15, v24, v91 row_newbcast:4 row_mask:0xf bank_mask:0xf
v_dot2c_f32_bf16_dpp v8, v24, v84 row_newbcast:5 row_mask:0xf bank_mask:0xf
v_dot2c_f32_bf16_dpp v9, v24, v96 row_newbcast:5 row_mask:0xf bank_mask:0xf
v_dot2c_f32_bf16_dpp v10, v24, v85 row_newbcast:5 row_mask:0xf bank_mask:0xf
v_dot2c_f32_bf16_dpp v11, v24, v97 row_newbcast:5 row_mask:0xf bank_mask:0xf
v_dot2c_f32_bf16_dpp v12, v24, v86 row_newbcast:5 row_mask:0xf bank_mask:0xf
v_dot2c_f32_bf16_dpp v13, v24, v98 row_newbcast:5 row_mask:0xf bank_mask:0xf
v_dot2c_f32_bf16_dpp v14, v24, v87 row_newbcast:5 row_mask:0xf bank_mask:0xf
v_dot2c_f32_bf16_dpp v15, v24, v99 row_newbcast:5 row_mask:0xf bank_mask:0xf
v_dot2c_f32_bf16_dpp v8, v24, v92 row_newbcast:6 row_mask:0xf bank_mask:0xf
v_dot2c_f32_bf16_dpp v9, v24, v104 row_newbcast:6 row_mask:0xf bank_mask:0xf
v_dot2c_f32_bf16_dpp v10, v24, v93 row_newbcast:6 row_mask:0xf bank_mask:0xf
v_dot2c_f32_bf16_dpp v11, v24, v105 row_newbcast:6 row_mask:0xf bank_mask:0xf
v_dot2c_f32_bf16_dpp v12, v24, v94 row_newbcast:6 row_mask:0xf bank_mask:0xf
v_dot2c_f32_bf16_dpp v13, v24, v106 row_newbcast:6 row_mask:0xf bank_mask:0xf
v_dot2c_f32_bf16_dpp v14, v24, v95 row_newbcast:6 row_mask:0xf bank_mask:0xf
v_dot2c_f32_bf16_dpp v15, v24, v107 row_newbcast:6 row_mask:0xf bank_mask:0xf
v_dot2c_f32_bf16_dpp v8, v24, v100 row_newbcast:7 row_mask:0xf bank_mask:0xf
v_dot2c_f32_bf16_dpp v9, v24, v112 row_newbcast:7 row_mask:0xf bank_mask:0xf
v_dot2c_f32_bf16_dpp v10, v24, v101 row_newbcast:7 row_mask:0xf bank_mask:0xf
v_dot2c_f32_bf16_dpp v11, v24, v113 row_newbcast:7 row_mask:0xf bank_mask:0xf
v_dot2c_f32_bf16_dpp v12, v24, v102 row_newbcast:7 row_mask:0xf bank_mask:0xf
v_dot2c_f32_bf16_dpp v13, v24, v114 row_newbcast:7 row_mask:0xf bank_mask:0xf
v_dot2c_f32_bf16_dpp v14, v24, v103 row_newbcast:7 row_mask:0xf bank_mask:0xf
v_dot2c_f32_bf16_dpp v15, v24, v115 row_newbcast:7 row_mask:0xf bank_mask:0xf
v_dot2c_f32_bf16_dpp v8, v24, v108 row_newbcast:8 row_mask:0xf bank_mask:0xf
v_dot2c_f32_bf16_dpp v9, v24, v120 row_newbcast:8 row_mask:0xf bank_mask:0xf
v_dot2c_f32_bf16_dpp v10, v24, v109 row_newbcast:8 row_mask:0xf bank_mask:0xf
v_dot2c_f32_bf16_dpp v11, v24, v121 row_newbcast:8 row_mask:0xf bank_mask:0xf
v_dot2c_f32_bf16_dpp v12, v24, v110 row_newbcast:8 row_mask:0xf bank_mask:0xf
v_dot2c_f32_bf16_dpp v13, v24, v122 row_newbcast:8 row_mask:0xf bank_mask:0xf
v_dot2c_f32_bf16_dpp v14, v24, v111 row_newbcast:8 row_mask:0xf bank_mask:0xf
v_dot2c_f32_bf16_dpp v15, v24, v123 row_newbcast:8 row_mask:0xf bank_mask:0xf
v_dot2c_f32_bf16_dpp v8, v24, v116 row_newbcast:9 row_mask:0xf bank_mask:0xf
v_dot2c_f32_bf16_dpp v9, v24, v128 row_newbcast:9 row_mask:0xf bank_mask:0xf
v_dot2c_f32_bf16_dpp v10, v24, v117 row_newbcast:9 row_mask:0xf bank_mask:0xf
v_dot2c_f32_bf16_dpp v11, v24, v129 row_newbcast:9 row_mask:0xf bank_mask:0xf
v_dot2c_f32_bf16_dpp v12, v24, v118 row_newbcast:9 row_mask:0xf bank_mask:0xf
v_dot2c_f32_bf16_dpp v13, v24, v130 row_newbcast:9 row_mask:0xf bank_mask:0xf
v_dot2c_f32_bf16_dpp v14, v24, v119 row_newbcast:9 row_mask:0xf bank_mask:0xf
v_dot2c_f32_bf16_dpp v15, v24, v131 row_newbcast:9 row_mask:0xf bank_mask:0xf
v_dot2c_f32_bf16_dpp v8, v24, v124 row_newbcast:10 row_mask:0xf bank_mask:0xf
v_dot2c_f32_bf16_dpp v9, v24, v136 row_newbcast:10 row_mask:0xf bank_mask:0xf
v_dot2c_f32_bf16_dpp v10, v24, v125 row_newbcast:10 row_mask:0xf bank_mask:0xf
v_dot2c_f32_bf16_dpp v11, v24, v137 row_newbcast:10 row_mask:0xf bank_mask:0xf
v_dot2c_f32_bf16_dpp v12, v24, v126 row_newbcast:10 row_mask:0xf bank_mask:0xf
v_dot2c_f32_bf16_dpp v13, v24, v138 row_newbcast:10 row_mask:0xf bank_mask:0xf
v_dot2c_f32_bf16_dpp v14, v24, v127 row_newbcast:10 row_mask:0xf bank_mask:0xf
v_dot2c_f32_bf16_dpp v15, v24, v139 row_newbcast:10 row_mask:0xf bank_mask:0xf
v_dot2c_f32_bf16_dpp v8, v24, v132 row_newbcast:11 row_mask:0xf bank_mask:0xf
v_dot2c_f32_bf16_dpp v9, v24, v144 row_newbcast:11 row_mask:0xf bank_mask:0xf
v_dot2c_f32_bf16_dpp v10, v24, v133 row_newbcast:11 row_mask:0xf bank_mask:0xf
v_dot2c_f32_bf16_dpp v11, v24, v145 row_newbcast:11 row_mask:0xf bank_mask:0xf
v_dot2c_f32_bf16_dpp v12, v24, v134 row_newbcast:11 row_mask:0xf bank_mask:0xf
v_dot2c_f32_bf16_dpp v13, v24, v146 row_newbcast:11 row_mask:0xf bank_mask:0xf
v_dot2c_f32_bf16_dpp v14, v24, v135 row_newbcast:11 row_mask:0xf bank_mask:0xf
v_dot2c_f32_bf16_dpp v15, v24, v147 row_newbcast:11 row_mask:0xf bank_mask:0xf
v_dot2c_f32_bf16_dpp v8, v24, v140 row_newbcast:12 row_mask:0xf bank_mask:0xf
v_dot2c_f32_bf16_dpp v9, v24, v152 row_newbcast:12 row_mask:0xf bank_mask:0xf
v_dot2c_f32_bf16_dpp v10, v24, v141 row_newbcast:12 row_mask:0xf bank_mask:0xf
v_dot2c_f32_bf16_dpp v11, v24, v153 row_newbcast:12 row_mask:0xf bank_mask:0xf
v_dot2c_f32_bf16_dpp v12, v24, v142 row_newbcast:12 row_mask:0xf bank_mask:0xf
v_dot2c_f32_bf16_dpp v13, v24, v154 row_newbcast:12 row_mask:0xf bank_mask:0xf
v_dot2c_f32_bf16_dpp v14, v24, v143 row_newbcast:12 row_mask:0xf bank_mask:0xf
v_dot2c_f32_bf16_dpp v15, v24, v155 row_newbcast:12 row_mask:0xf bank_mask:0xf
v_dot2c_f32_bf16_dpp v8, v24, v148 row_newbcast:13 row_mask:0xf bank_mask:0xf
v_dot2c_f32_bf16_dpp v9, v24, v160 row_newbcast:13 row_mask:0xf bank_mask:0xf
v_dot2c_f32_bf16_dpp v10, v24, v149 row_newbcast:13 row_mask:0xf bank_mask:0xf
v_dot2c_f32_bf16_dpp v11, v24, v161 row_newbcast:13 row_mask:0xf bank_mask:0xf
v_dot2c_f32_bf16_dpp v12, v24, v150 row_newbcast:13 row_mask:0xf bank_mask:0xf
v_dot2c_f32_bf16_dpp v13, v24, v162 row_newbcast:13 row_mask:0xf bank_mask:0xf
v_dot2c_f32_bf16_dpp v14, v24, v151 row_newbcast:13 row_mask:0xf bank_mask:0xf
v_dot2c_f32_bf16_dpp v15, v24, v163 row_newbcast:13 row_mask:0xf bank_mask:0xf
v_dot2c_f32_bf16_dpp v8, v24, v156 row_newbcast:14 row_mask:0xf bank_mask:0xf
v_dot2c_f32_bf16_dpp v9, v24, v168 row_newbcast:14 row_mask:0xf bank_mask:0xf
v_dot2c_f32_bf16_dpp v10, v24, v157 row_newbcast:14 row_mask:0xf bank_mask:0xf
v_dot2c_f32_bf16_dpp v11, v24, v169 row_newbcast:14 row_mask:0xf bank_mask:0xf
v_dot2c_f32_bf16_dpp v12, v24, v158 row_newbcast:14 row_mask:0xf bank_mask:0xf
v_dot2c_f32_bf16_dpp v13, v24, v170 row_newbcast:14 row_mask:0xf bank_mask:0xf
v_dot2c_f32_bf16_dpp v14, v24, v159 row_newbcast:14 row_mask:0xf bank_mask:0xf
v_dot2c_f32_bf16_dpp v15, v24, v171 row_newbcast:14 row_mask:0xf bank_mask:0xf
v_dot2c_f32_bf16_dpp v8, v24, v164 row_newbcast:15 row_mask:0xf bank_mask:0xf
v_dot2c_f32_bf16_dpp v9, v24, v176 row_newbcast:15 row_mask:0xf bank_mask:0xf
v_dot2c_f32_bf16_dpp v10, v24, v165 row_newbcast:15 row_mask:0xf bank_mask:0xf
v_dot2c_f32_bf16_dpp v11, v24, v177 row_newbcast:15 row_mask:0xf bank_mask:0xf
v_dot2c_f32_bf16_dpp v12, v24, v166 row_newbcast:15 row_mask:0xf bank_mask:0xf
v_dot2c_f32_bf16_dpp v13, v24, v178 row_newbcast:15 row_mask:0xf bank_mask:0xf
v_dot2c_f32_bf16_dpp v14, v24, v167 row_newbcast:15 row_mask:0xf bank_mask:0xf
v_dot2c_f32_bf16_dpp v15, v24, v179 row_newbcast:15 row_mask:0xf bank_mask:0xf
s_nop 2
ds_write_b128 v44, v[8:11] offset:18048
ds_write_b128 v44, v[12:15] offset:19200
s_add_u32 s48, s22, s71
s_addc_u32 s49, s23, 0
s_lshl_b32 s72, s74, 11
buffer_load_dwordx4 v[52:55], v42, s[48:51], s72 offen offset:0
buffer_load_dwordx4 v[56:59], v42, s[48:51], s72 offen offset:1024
buffer_load_dwordx4 v[60:63], v42, s[48:51], s72 offen offset:2048
buffer_load_dwordx4 v[64:67], v42, s[48:51], s72 offen offset:3072
s_add_u32 s72, s72, 4096
s_and_b32 s72, s72, 0x7fff
buffer_load_dwordx4 v[68:71], v42, s[48:51], s72 offen offset:0
buffer_load_dwordx4 v[72:75], v42, s[48:51], s72 offen offset:1024
buffer_load_dwordx4 v[76:79], v42, s[48:51], s72 offen offset:2048
buffer_load_dwordx4 v[80:83], v42, s[48:51], s72 offen offset:3072
s_add_u32 s72, s72, 4096
s_and_b32 s72, s72, 0x7fff
buffer_load_dwordx4 v[84:87], v42, s[48:51], s72 offen offset:0
buffer_load_dwordx4 v[88:91], v42, s[48:51], s72 offen offset:1024
buffer_load_dwordx4 v[92:95], v42, s[48:51], s72 offen offset:2048
buffer_load_dwordx4 v[96:99], v42, s[48:51], s72 offen offset:3072
s_add_u32 s72, s72, 4096
s_and_b32 s72, s72, 0x7fff
buffer_load_dwordx4 v[100:103], v42, s[48:51], s72 offen offset:0
buffer_load_dwordx4 v[104:107], v42, s[48:51], s72 offen offset:1024
buffer_load_dwordx4 v[108:111], v42, s[48:51], s72 offen offset:2048
buffer_load_dwordx4 v[112:115], v42, s[48:51], s72 offen offset:3072
s_add_u32 s72, s72, 4096
s_and_b32 s72, s72, 0x7fff
buffer_load_dwordx4 v[116:119], v42, s[48:51], s72 offen offset:0
buffer_load_dwordx4 v[120:123], v42, s[48:51], s72 offen offset:1024
buffer_load_dwordx4 v[124:127], v42, s[48:51], s72 offen offset:2048
buffer_load_dwordx4 v[128:131], v42, s[48:51], s72 offen offset:3072
s_add_u32 s72, s72, 4096
s_and_b32 s72, s72, 0x7fff
buffer_load_dwordx4 v[132:135], v42, s[48:51], s72 offen offset:0
buffer_load_dwordx4 v[136:139], v42, s[48:51], s72 offen offset:1024
buffer_load_dwordx4 v[140:143], v42, s[48:51], s72 offen offset:2048
buffer_load_dwordx4 v[144:147], v42, s[48:51], s72 offen offset:3072
s_add_u32 s72, s72, 4096
s_and_b32 s72, s72, 0x7fff
buffer_load_dwordx4 v[148:151], v42, s[48:51], s72 offen offset:0
buffer_load_dwordx4 v[152:155], v42, s[48:51], s72 offen offset:1024
buffer_load_dwordx4 v[156:159], v42, s[48:51], s72 offen offset:2048
buffer_load_dwordx4 v[160:163], v42, s[48:51], s72 offen offset:3072
s_add_u32 s72, s72, 4096
s_and_b32 s72, s72, 0x7fff
buffer_load_dwordx4 v[164:167], v42, s[48:51], s72 offen offset:0
buffer_load_dwordx4 v[168:171], v42, s[48:51], s72 offen offset:1024
buffer_load_dwordx4 v[172:175], v42, s[48:51], s72 offen offset:2048
buffer_load_dwordx4 v[176:179], v42, s[48:51], s72 offen offset:3072
s_add_u32 s72, s72, 4096
s_and_b32 s72, s72, 0x7fff
s_waitcnt vmcnt(30)
v_perm_b32 v48, v56, v52, s64
v_perm_b32 v56, v56, v52, s65
v_perm_b32 v49, v57, v53, s64
v_perm_b32 v57, v57, v53, s65
v_perm_b32 v50, v58, v54, s64
v_perm_b32 v58, v58, v54, s65
v_perm_b32 v51, v59, v55, s64
v_perm_b32 v59, v59, v55, s65
s_waitcnt vmcnt(28)
v_perm_b32 v52, v64, v60, s64
v_perm_b32 v64, v64, v60, s65
v_perm_b32 v53, v65, v61, s64
v_perm_b32 v65, v65, v61, s65
v_perm_b32 v54, v66, v62, s64
v_perm_b32 v66, v66, v62, s65
v_perm_b32 v55, v67, v63, s64
v_perm_b32 v67, v67, v63, s65
s_waitcnt vmcnt(26)
v_perm_b32 v60, v72, v68, s64
v_perm_b32 v72, v72, v68, s65
v_perm_b32 v61, v73, v69, s64
v_perm_b32 v73, v73, v69, s65
v_perm_b32 v62, v74, v70, s64
v_perm_b32 v74, v74, v70, s65
v_perm_b32 v63, v75, v71, s64
v_perm_b32 v75, v75, v71, s65
s_waitcnt vmcnt(24)
v_perm_b32 v68, v80, v76, s64
v_perm_b32 v80, v80, v76, s65
v_perm_b32 v69, v81, v77, s64
v_perm_b32 v81, v81, v77, s65
v_perm_b32 v70, v82, v78, s64
v_perm_b32 v82, v82, v78, s65
v_perm_b32 v71, v83, v79, s64
v_perm_b32 v83, v83, v79, s65
s_waitcnt vmcnt(22)
v_perm_b32 v76, v88, v84, s64
v_perm_b32 v88, v88, v84, s65
v_perm_b32 v77, v89, v85, s64
v_perm_b32 v89, v89, v85, s65
v_perm_b32 v78, v90, v86, s64
v_perm_b32 v90, v90, v86, s65
v_perm_b32 v79, v91, v87, s64
v_perm_b32 v91, v91, v87, s65
s_waitcnt vmcnt(20)
v_perm_b32 v84, v96, v92, s64
v_perm_b32 v96, v96, v92, s65
v_perm_b32 v85, v97, v93, s64
v_perm_b32 v97, v97, v93, s65
v_perm_b32 v86, v98, v94, s64
v_perm_b32 v98, v98, v94, s65
v_perm_b32 v87, v99, v95, s64
v_perm_b32 v99, v99, v95, s65
s_waitcnt vmcnt(18)
v_perm_b32 v92, v104, v100, s64
v_perm_b32 v104, v104, v100, s65
v_perm_b32 v93, v105, v101, s64
v_perm_b32 v105, v105, v101, s65
v_perm_b32 v94, v106, v102, s64
v_perm_b32 v106, v106, v102, s65
v_perm_b32 v95, v107, v103, s64
v_perm_b32 v107, v107, v103, s65
s_waitcnt vmcnt(16)
v_perm_b32 v100, v112, v108, s64
v_perm_b32 v112, v112, v108, s65
v_perm_b32 v101, v113, v109, s64
v_perm_b32 v113, v113, v109, s65
v_perm_b32 v102, v114, v110, s64
v_perm_b32 v114, v114, v110, s65
v_perm_b32 v103, v115, v111, s64
v_perm_b32 v115, v115, v111, s65
s_waitcnt vmcnt(14)
v_perm_b32 v108, v120, v116, s64
v_perm_b32 v120, v120, v116, s65
v_perm_b32 v109, v121, v117, s64
v_perm_b32 v121, v121, v117, s65
v_perm_b32 v110, v122, v118, s64
v_perm_b32 v122, v122, v118, s65
v_perm_b32 v111, v123, v119, s64
v_perm_b32 v123, v123, v119, s65
s_waitcnt vmcnt(12)
v_perm_b32 v116, v128, v124, s64
v_perm_b32 v128, v128, v124, s65
v_perm_b32 v117, v129, v125, s64
v_perm_b32 v129, v129, v125, s65
v_perm_b32 v118, v130, v126, s64
v_perm_b32 v130, v130, v126, s65
v_perm_b32 v119, v131, v127, s64
v_perm_b32 v131, v131, v127, s65
s_waitcnt vmcnt(10)
v_perm_b32 v124, v136, v132, s64
v_perm_b32 v136, v136, v132, s65
v_perm_b32 v125, v137, v133, s64
v_perm_b32 v137, v137, v133, s65
v_perm_b32 v126, v138, v134, s64
v_perm_b32 v138, v138, v134, s65
v_perm_b32 v127, v139, v135, s64
v_perm_b32 v139, v139, v135, s65
s_waitcnt vmcnt(8)
v_perm_b32 v132, v144, v140, s64
v_perm_b32 v144, v144, v140, s65
v_perm_b32 v133, v145, v141, s64
v_perm_b32 v145, v145, v141, s65
v_perm_b32 v134, v146, v142, s64
v_perm_b32 v146, v146, v142, s65
v_perm_b32 v135, v147, v143, s64
v_perm_b32 v147, v147, v143, s65
s_waitcnt vmcnt(6)
v_perm_b32 v140, v152, v148, s64
v_perm_b32 v152, v152, v148, s65
v_perm_b32 v141, v153, v149, s64
v_perm_b32 v153, v153, v149, s65
v_perm_b32 v142, v154, v150, s64
v_perm_b32 v154, v154, v150, s65
v_perm_b32 v143, v155, v151, s64
v_perm_b32 v155, v155, v151, s65
s_waitcnt vmcnt(4)
v_perm_b32 v148, v160, v156, s64
v_perm_b32 v160, v160, v156, s65
v_perm_b32 v149, v161, v157, s64
v_perm_b32 v161, v161, v157, s65
v_perm_b32 v150, v162, v158, s64
v_perm_b32 v162, v162, v158, s65
v_perm_b32 v151, v163, v159, s64
v_perm_b32 v163, v163, v159, s65
s_waitcnt vmcnt(2)
v_perm_b32 v156, v168, v164, s64
v_perm_b32 v168, v168, v164, s65
v_perm_b32 v157, v169, v165, s64
v_perm_b32 v169, v169, v165, s65
v_perm_b32 v158, v170, v166, s64
v_perm_b32 v170, v170, v166, s65
v_perm_b32 v159, v171, v167, s64
v_perm_b32 v171, v171, v167, s65
s_waitcnt vmcnt(0)
v_perm_b32 v164, v176, v172, s64
v_perm_b32 v176, v176, v172, s65
v_perm_b32 v165, v177, v173, s64
v_perm_b32 v177, v177, v173, s65
v_perm_b32 v166, v178, v174, s64
v_perm_b32 v178, v178, v174, s65
v_perm_b32 v167, v179, v175, s64
v_perm_b32 v179, v179, v175, s65
v_mov_b32 v8, 0
v_mov_b32 v9, 0
v_mov_b32 v10, 0
v_mov_b32 v11, 0
v_mov_b32 v12, 0
v_mov_b32 v13, 0
v_mov_b32 v14, 0
v_mov_b32 v15, 0
s_waitcnt lgkmcnt(0)
s_barrier
ds_read_b64 v[16:17], v45 offset:18048
ds_read_b64 v[18:19], v45 offset:20352
ds_read_b64 v[20:21], v45 offset:22656
ds_read_b64 v[22:23], v45 offset:24960
s_waitcnt lgkmcnt(2)
v_add_f32 v16, v16, v18
v_add_f32 v17, v17, v19
s_waitcnt lgkmcnt(0)
v_add_f32 v20, v20, v22
v_add_f32 v21, v21, v23
v_add_f32 v16, v16, v20
v_add_f32 v17, v17, v21
buffer_store_dwordx2 v[16:17], v46, s[56:59], s76 offen
s_barrier
s_cmp_lg_u32 s62, 0
s_cbranch_scc1 L_nostatb
ds_read_b32 v24, v47 offset:17920
ds_read_b32 v25, v47 offset:17984
s_waitcnt lgkmcnt(0)
s_nop 0
v_max_f32_dpp v24, v24, v24 row_ror:8 row_mask:0xf bank_mask:0xf
v_add_f32_dpp v25, v25, v25 row_ror:8 row_mask:0xf bank_mask:0xf
s_nop 0
v_max_f32_dpp v24, v24, v24 row_ror:4 row_mask:0xf bank_mask:0xf
v_add_f32_dpp v25, v25, v25 row_ror:4 row_mask:0xf bank_mask:0xf
s_nop 0
v_max_f32_dpp v24, v24, v24 row_ror:2 row_mask:0xf bank_mask:0xf
v_add_f32_dpp v25, v25, v25 row_ror:2 row_mask:0xf bank_mask:0xf
s_nop 0
v_max_f32_dpp v24, v24, v24 row_ror:1 row_mask:0xf bank_mask:0xf
v_add_f32_dpp v25, v25, v25 row_ror:1 row_mask:0xf bank_mask:0xf
v_mul_f32 v24, s63, v24
s_lshl_b32 s72, s69, 3
s_add_u32 s72, s72, 1050624
s_mov_b64 exec, 1
buffer_store_dwordx2 v[24:25], v38, s[56:59], s72 offen
s_mov_b64 exec, -1
L_nostatb:
s_add_u32 s76, s76, 524288
s_barrier
ds_read_b64 v[16:17], v33 offset:0
ds_read_b64 v[18:19], v33 offset:256
ds_read_b64 v[20:21], v33 offset:512
ds_read_b64 v[22:23], v33 offset:768
s_waitcnt lgkmcnt(2)
v_add_f32 v16, v16, v18
v_add_f32 v17, v17, v19
s_waitcnt lgkmcnt(0)
v_add_f32 v20, v20, v22
v_add_f32 v21, v21, v23
v_add_f32 v16, v16, v20
v_add_f32 v17, v17, v21
v_mov_b32 v18, v16
v_mov_b32 v19, v17
s_nop 0
v_permlane16_swap_b32 v16, v18
v_permlane16_swap_b32 v17, v19
s_nop 0
v_add_f32 v16, v16, v18
v_add_f32 v17, v17, v19
v_mov_b32 v18, v16
v_mov_b32 v19, v17
s_nop 0
v_permlane32_swap_b32 v16, v18
v_permlane32_swap_b32 v17, v19
s_nop 0
v_add_f32 v16, v16, v18
v_add_f32 v17, v17, v19
v_cvt_pk_bf16_f32 v24, v16, v17
s_nop 1
v_dot2c_f32_bf16_dpp v8, v24, v48 row_newbcast:0 row_mask:0xf bank_mask:0xf
v_dot2c_f32_bf16_dpp v9, v24, v56 row_newbcast:0 row_mask:0xf bank_mask:0xf
v_dot2c_f32_bf16_dpp v10, v24, v49 row_newbcast:0 row_mask:0xf bank_mask:0xf
v_dot2c_f32_bf16_dpp v11, v24, v57 row_newbcast:0 row_mask:0xf bank_mask:0xf
v_dot2c_f32_bf16_dpp v12, v24, v50 row_newbcast:0 row_mask:0xf bank_mask:0xf
v_dot2c_f32_bf16_dpp v13, v24, v58 row_newbcast:0 row_mask:0xf bank_mask:0xf
v_dot2c_f32_bf16_dpp v14, v24, v51 row_newbcast:0 row_mask:0xf bank_mask:0xf
v_dot2c_f32_bf16_dpp v15, v24, v59 row_newbcast:0 row_mask:0xf bank_mask:0xf
v_dot2c_f32_bf16_dpp v8, v24, v52 row_newbcast:1 row_mask:0xf bank_mask:0xf
v_dot2c_f32_bf16_dpp v9, v24, v64 row_newbcast:1 row_mask:0xf bank_mask:0xf
v_dot2c_f32_bf16_dpp v10, v24, v53 row_newbcast:1 row_mask:0xf bank_mask:0xf
v_dot2c_f32_bf16_dpp v11, v24, v65 row_newbcast:1 row_mask:0xf bank_mask:0xf
v_dot2c_f32_bf16_dpp v12, v24, v54 row_newbcast:1 row_mask:0xf bank_mask:0xf
v_dot2c_f32_bf16_dpp v13, v24, v66 row_newbcast:1 row_mask:0xf bank_mask:0xf
v_dot2c_f32_bf16_dpp v14, v24, v55 row_newbcast:1 row_mask:0xf bank_mask:0xf
v_dot2c_f32_bf16_dpp v15, v24, v67 row_newbcast:1 row_mask:0xf bank_mask:0xf
v_dot2c_f32_bf16_dpp v8, v24, v60 row_newbcast:2 row_mask:0xf bank_mask:0xf
v_dot2c_f32_bf16_dpp v9, v24, v72 row_newbcast:2 row_mask:0xf bank_mask:0xf
v_dot2c_f32_bf16_dpp v10, v24, v61 row_newbcast:2 row_mask:0xf bank_mask:0xf
v_dot2c_f32_bf16_dpp v11, v24, v73 row_newbcast:2 row_mask:0xf bank_mask:0xf
v_dot2c_f32_bf16_dpp v12, v24, v62 row_newbcast:2 row_mask:0xf bank_mask:0xf
v_dot2c_f32_bf16_dpp v13, v24, v74 row_newbcast:2 row_mask:0xf bank_mask:0xf
v_dot2c_f32_bf16_dpp v14, v24, v63 row_newbcast:2 row_mask:0xf bank_mask:0xf
v_dot2c_f32_bf16_dpp v15, v24, v75 row_newbcast:2 row_mask:0xf bank_mask:0xf
v_dot2c_f32_bf16_dpp v8, v24, v68 row_newbcast:3 row_mask:0xf bank_mask:0xf
v_dot2c_f32_bf16_dpp v9, v24, v80 row_newbcast:3 row_mask:0xf bank_mask:0xf
v_dot2c_f32_bf16_dpp v10, v24, v69 row_newbcast:3 row_mask:0xf bank_mask:0xf
v_dot2c_f32_bf16_dpp v11, v24, v81 row_newbcast:3 row_mask:0xf bank_mask:0xf
v_dot2c_f32_bf16_dpp v12, v24, v70 row_newbcast:3 row_mask:0xf bank_mask:0xf
v_dot2c_f32_bf16_dpp v13, v24, v82 row_newbcast:3 row_mask:0xf bank_mask:0xf
v_dot2c_f32_bf16_dpp v14, v24, v71 row_newbcast:3 row_mask:0xf bank_mask:0xf
v_dot2c_f32_bf16_dpp v15, v24, v83 row_newbcast:3 row_mask:0xf bank_mask:0xf
v_dot2c_f32_bf16_dpp v8, v24, v76 row_newbcast:4 row_mask:0xf bank_mask:0xf
v_dot2c_f32_bf16_dpp v9, v24, v88 row_newbcast:4 row_mask:0xf bank_mask:0xf
v_dot2c_f32_bf16_dpp v10, v24, v77 row_newbcast:4 row_mask:0xf bank_mask:0xf
v_dot2c_f32_bf16_dpp v11, v24, v89 row_newbcast:4 row_mask:0xf bank_mask:0xf
v_dot2c_f32_bf16_dpp v12, v24, v78 row_newbcast:4 row_mask:0xf bank_mask:0xf
v_dot2c_f32_bf16_dpp v13, v24, v90 row_newbcast:4 row_mask:0xf bank_mask:0xf
v_dot2c_f32_bf16_dpp v14, v24, v79 row_newbcast:4 row_mask:0xf bank_mask:0xf
v_dot2c_f32_bf16_dpp v15, v24, v91 row_newbcast:4 row_mask:0xf bank_mask:0xf
v_dot2c_f32_bf16_dpp v8, v24, v84 row_newbcast:5 row_mask:0xf bank_mask:0xf
v_dot2c_f32_bf16_dpp v9, v24, v96 row_newbcast:5 row_mask:0xf bank_mask:0xf
v_dot2c_f32_bf16_dpp v10, v24, v85 row_newbcast:5 row_mask:0xf bank_mask:0xf
v_dot2c_f32_bf16_dpp v11, v24, v97 row_newbcast:5 row_mask:0xf bank_mask:0xf
v_dot2c_f32_bf16_dpp v12, v24, v86 row_newbcast:5 row_mask:0xf bank_mask:0xf
v_dot2c_f32_bf16_dpp v13, v24, v98 row_newbcast:5 row_mask:0xf bank_mask:0xf
v_dot2c_f32_bf16_dpp v14, v24, v87 row_newbcast:5 row_mask:0xf bank_mask:0xf
v_dot2c_f32_bf16_dpp v15, v24, v99 row_newbcast:5 row_mask:0xf bank_mask:0xf
v_dot2c_f32_bf16_dpp v8, v24, v92 row_newbcast:6 row_mask:0xf bank_mask:0xf
v_dot2c_f32_bf16_dpp v9, v24, v104 row_newbcast:6 row_mask:0xf bank_mask:0xf
v_dot2c_f32_bf16_dpp v10, v24, v93 row_newbcast:6 row_mask:0xf bank_mask:0xf
v_dot2c_f32_bf16_dpp v11, v24, v105 row_newbcast:6 row_mask:0xf bank_mask:0xf
v_dot2c_f32_bf16_dpp v12, v24, v94 row_newbcast:6 row_mask:0xf bank_mask:0xf
v_dot2c_f32_bf16_dpp v13, v24, v106 row_newbcast:6 row_mask:0xf bank_mask:0xf
v_dot2c_f32_bf16_dpp v14, v24, v95 row_newbcast:6 row_mask:0xf bank_mask:0xf
v_dot2c_f32_bf16_dpp v15, v24, v107 row_newbcast:6 row_mask:0xf bank_mask:0xf
v_dot2c_f32_bf16_dpp v8, v24, v100 row_newbcast:7 row_mask:0xf bank_mask:0xf
v_dot2c_f32_bf16_dpp v9, v24, v112 row_newbcast:7 row_mask:0xf bank_mask:0xf
v_dot2c_f32_bf16_dpp v10, v24, v101 row_newbcast:7 row_mask:0xf bank_mask:0xf
v_dot2c_f32_bf16_dpp v11, v24, v113 row_newbcast:7 row_mask:0xf bank_mask:0xf
v_dot2c_f32_bf16_dpp v12, v24, v102 row_newbcast:7 row_mask:0xf bank_mask:0xf
v_dot2c_f32_bf16_dpp v13, v24, v114 row_newbcast:7 row_mask:0xf bank_mask:0xf
v_dot2c_f32_bf16_dpp v14, v24, v103 row_newbcast:7 row_mask:0xf bank_mask:0xf
v_dot2c_f32_bf16_dpp v15, v24, v115 row_newbcast:7 row_mask:0xf bank_mask:0xf
v_dot2c_f32_bf16_dpp v8, v24, v108 row_newbcast:8 row_mask:0xf bank_mask:0xf
v_dot2c_f32_bf16_dpp v9, v24, v120 row_newbcast:8 row_mask:0xf bank_mask:0xf
v_dot2c_f32_bf16_dpp v10, v24, v109 row_newbcast:8 row_mask:0xf bank_mask:0xf
v_dot2c_f32_bf16_dpp v11, v24, v121 row_newbcast:8 row_mask:0xf bank_mask:0xf
v_dot2c_f32_bf16_dpp v12, v24, v110 row_newbcast:8 row_mask:0xf bank_mask:0xf
v_dot2c_f32_bf16_dpp v13, v24, v122 row_newbcast:8 row_mask:0xf bank_mask:0xf
v_dot2c_f32_bf16_dpp v14, v24, v111 row_newbcast:8 row_mask:0xf bank_mask:0xf
v_dot2c_f32_bf16_dpp v15, v24, v123 row_newbcast:8 row_mask:0xf bank_mask:0xf
v_dot2c_f32_bf16_dpp v8, v24, v116 row_newbcast:9 row_mask:0xf bank_mask:0xf
v_dot2c_f32_bf16_dpp v9, v24, v128 row_newbcast:9 row_mask:0xf bank_mask:0xf
v_dot2c_f32_bf16_dpp v10, v24, v117 row_newbcast:9 row_mask:0xf bank_mask:0xf
v_dot2c_f32_bf16_dpp v11, v24, v129 row_newbcast:9 row_mask:0xf bank_mask:0xf
v_dot2c_f32_bf16_dpp v12, v24, v118 row_newbcast:9 row_mask:0xf bank_mask:0xf
v_dot2c_f32_bf16_dpp v13, v24, v130 row_newbcast:9 row_mask:0xf bank_mask:0xf
v_dot2c_f32_bf16_dpp v14, v24, v119 row_newbcast:9 row_mask:0xf bank_mask:0xf
v_dot2c_f32_bf16_dpp v15, v24, v131 row_newbcast:9 row_mask:0xf bank_mask:0xf
v_dot2c_f32_bf16_dpp v8, v24, v124 row_newbcast:10 row_mask:0xf bank_mask:0xf
v_dot2c_f32_bf16_dpp v9, v24, v136 row_newbcast:10 row_mask:0xf bank_mask:0xf
v_dot2c_f32_bf16_dpp v10, v24, v125 row_newbcast:10 row_mask:0xf bank_mask:0xf
v_dot2c_f32_bf16_dpp v11, v24, v137 row_newbcast:10 row_mask:0xf bank_mask:0xf
v_dot2c_f32_bf16_dpp v12, v24, v126 row_newbcast:10 row_mask:0xf bank_mask:0xf
v_dot2c_f32_bf16_dpp v13, v24, v138 row_newbcast:10 row_mask:0xf bank_mask:0xf
v_dot2c_f32_bf16_dpp v14, v24, v127 row_newbcast:10 row_mask:0xf bank_mask:0xf
v_dot2c_f32_bf16_dpp v15, v24, v139 row_newbcast:10 row_mask:0xf bank_mask:0xf
v_dot2c_f32_bf16_dpp v8, v24, v132 row_newbcast:11 row_mask:0xf bank_mask:0xf
v_dot2c_f32_bf16_dpp v9, v24, v144 row_newbcast:11 row_mask:0xf bank_mask:0xf
v_dot2c_f32_bf16_dpp v10, v24, v133 row_newbcast:11 row_mask:0xf bank_mask:0xf
v_dot2c_f32_bf16_dpp v11, v24, v145 row_newbcast:11 row_mask:0xf bank_mask:0xf
v_dot2c_f32_bf16_dpp v12, v24, v134 row_newbcast:11 row_mask:0xf bank_mask:0xf
v_dot2c_f32_bf16_dpp v13, v24, v146 row_newbcast:11 row_mask:0xf bank_mask:0xf
v_dot2c_f32_bf16_dpp v14, v24, v135 row_newbcast:11 row_mask:0xf bank_mask:0xf
v_dot2c_f32_bf16_dpp v15, v24, v147 row_newbcast:11 row_mask:0xf bank_mask:0xf
v_dot2c_f32_bf16_dpp v8, v24, v140 row_newbcast:12 row_mask:0xf bank_mask:0xf
v_dot2c_f32_bf16_dpp v9, v24, v152 row_newbcast:12 row_mask:0xf bank_mask:0xf
v_dot2c_f32_bf16_dpp v10, v24, v141 row_newbcast:12 row_mask:0xf bank_mask:0xf
v_dot2c_f32_bf16_dpp v11, v24, v153 row_newbcast:12 row_mask:0xf bank_mask:0xf
v_dot2c_f32_bf16_dpp v12, v24, v142 row_newbcast:12 row_mask:0xf bank_mask:0xf
v_dot2c_f32_bf16_dpp v13, v24, v154 row_newbcast:12 row_mask:0xf bank_mask:0xf
v_dot2c_f32_bf16_dpp v14, v24, v143 row_newbcast:12 row_mask:0xf bank_mask:0xf
v_dot2c_f32_bf16_dpp v15, v24, v155 row_newbcast:12 row_mask:0xf bank_mask:0xf
v_dot2c_f32_bf16_dpp v8, v24, v148 row_newbcast:13 row_mask:0xf bank_mask:0xf
v_dot2c_f32_bf16_dpp v9, v24, v160 row_newbcast:13 row_mask:0xf bank_mask:0xf
v_dot2c_f32_bf16_dpp v10, v24, v149 row_newbcast:13 row_mask:0xf bank_mask:0xf
v_dot2c_f32_bf16_dpp v11, v24, v161 row_newbcast:13 row_mask:0xf bank_mask:0xf
v_dot2c_f32_bf16_dpp v12, v24, v150 row_newbcast:13 row_mask:0xf bank_mask:0xf
v_dot2c_f32_bf16_dpp v13, v24, v162 row_newbcast:13 row_mask:0xf bank_mask:0xf
v_dot2c_f32_bf16_dpp v14, v24, v151 row_newbcast:13 row_mask:0xf bank_mask:0xf
v_dot2c_f32_bf16_dpp v15, v24, v163 row_newbcast:13 row_mask:0xf bank_mask:0xf
v_dot2c_f32_bf16_dpp v8, v24, v156 row_newbcast:14 row_mask:0xf bank_mask:0xf
v_dot2c_f32_bf16_dpp v9, v24, v168 row_newbcast:14 row_mask:0xf bank_mask:0xf
v_dot2c_f32_bf16_dpp v10, v24, v157 row_newbcast:14 row_mask:0xf bank_mask:0xf
v_dot2c_f32_bf16_dpp v11, v24, v169 row_newbcast:14 row_mask:0xf bank_mask:0xf
v_dot2c_f32_bf16_dpp v12, v24, v158 row_newbcast:14 row_mask:0xf bank_mask:0xf
v_dot2c_f32_bf16_dpp v13, v24, v170 row_newbcast:14 row_mask:0xf bank_mask:0xf
v_dot2c_f32_bf16_dpp v14, v24, v159 row_newbcast:14 row_mask:0xf bank_mask:0xf
v_dot2c_f32_bf16_dpp v15, v24, v171 row_newbcast:14 row_mask:0xf bank_mask:0xf
v_dot2c_f32_bf16_dpp v8, v24, v164 row_newbcast:15 row_mask:0xf bank_mask:0xf
v_dot2c_f32_bf16_dpp v9, v24, v176 row_newbcast:15 row_mask:0xf bank_mask:0xf
v_dot2c_f32_bf16_dpp v10, v24, v165 row_newbcast:15 row_mask:0xf bank_mask:0xf
v_dot2c_f32_bf16_dpp v11, v24, v177 row_newbcast:15 row_mask:0xf bank_mask:0xf
v_dot2c_f32_bf16_dpp v12, v24, v166 row_newbcast:15 row_mask:0xf bank_mask:0xf
v_dot2c_f32_bf16_dpp v13, v24, v178 row_newbcast:15 row_mask:0xf bank_mask:0xf
v_dot2c_f32_bf16_dpp v14, v24, v167 row_newbcast:15 row_mask:0xf bank_mask:0xf
v_dot2c_f32_bf16_dpp v15, v24, v179 row_newbcast:15 row_mask:0xf bank_mask:0xf
s_nop 2
ds_write_b128 v44, v[8:11] offset:18048
ds_write_b128 v44, v[12:15] offset:19200
s_waitcnt lgkmcnt(0)
s_barrier
ds_read_b64 v[16:17], v45 offset:18048
ds_read_b64 v[18:19], v45 offset:20352
ds_read_b64 v[20:21], v45 offset:22656
ds_read_b64 v[22:23], v45 offset:24960
s_waitcnt lgkmcnt(2)
v_add_f32 v16, v16, v18
v_add_f32 v17, v17, v19
s_waitcnt lgkmcnt(0)
v_add_f32 v20, v20, v22
v_add_f32 v21, v21, v23
v_add_f32 v16, v16, v20
v_add_f32 v17, v17, v21
buffer_store_dwordx2 v[16:17], v46, s[56:59], s76 offen
s_endpgm
.p2align 6
L_stream:
L_stream2:
s_add_u32 s40, s8, s30
s_addc_u32 s41, s9, 0
s_add_u32 s42, s16, s30
s_addc_u32 s43, s17, 0
s_add_u32 s44, s18, s30
s_addc_u32 s45, s19, 0
s_mov_b32 s63, 1040356334
s_mov_b32 s64, 0xcccccccc
s_mov_b32 s65, 0xcccccccc
s_mov_b32 s66, 0xaaaaaaaa
s_mov_b32 s67, 0xaaaaaaaa
s_sub_u32 s73, s62, 4
s_mul_i32 s72, s73, 2176
v_lshlrev_b32 v34, 4, v2
v_add_u32 v34, s72, v34
s_lshl_b32 s72, s73, 11
s_add_u32 s72, s72, 27264
v_lshlrev_b32 v29, 2, v2
v_add_u32 v29, s72, v29
v_and_b32 v37, 15, v0
v_lshlrev_b32 v38, 4, v37
v_lshlrev_b32 v37, 2, v37
v_bfe_u32 v36, v0, 4, 4
v_lshlrev_b32 v36, 2, v36
s_mov_b32 s46, 524288
s_barrier
s_barrier
s_setprio 2
ds_read_b128 v[4:7], v38 offset:17408
L_set:
v_mov_b32 v28, 0xff800000
v_mov_b32 v8, 0
v_mov_b32 v9, 0
v_mov_b32 v10, 0
v_mov_b32 v11, 0
v_mov_b32 v12, 0
v_mov_b32 v13, 0
v_mov_b32 v14, 0
v_mov_b32 v15, 0
s_mov_b32 s61, 0
s_waitcnt lgkmcnt(0)
.p2align 3
L_k:
s_waitcnt vmcnt(4)
buffer_load_dwordx4 v[80:83], v1, s[36:39], s60 offen offset:0 nt
buffer_load_dwordx4 v[84:87], v1, s[36:39], s60 offen offset:1024 nt
buffer_load_dwordx4 v[88:91], v1, s[36:39], s60 offen offset:2048 nt
buffer_load_dwordx4 v[92:95], v1, s[36:39], s60 offen offset:3072 nt
s_add_u32 s60, s60, 16384
s_and_b32 s60, s60, 524287
v_dot2_f32_bf16 v16, v48, v4, 0
v_dot2_f32_bf16 v17, v52, v4, 0
v_dot2_f32_bf16 v18, v56, v4, 0
v_dot2_f32_bf16 v19, v60, v4, 0
v_dot2_f32_bf16 v16, v49, v5, v16
v_dot2_f32_bf16 v17, v53, v5, v17
v_dot2_f32_bf16 v18, v57, v5, v18
v_dot2_f32_bf16 v19, v61, v5, v19
v_dot2_f32_bf16 v16, v50, v6, v16
v_dot2_f32_bf16 v17, v54, v6, v17
v_dot2_f32_bf16 v18, v58, v6, v18
v_dot2_f32_bf16 v19, v62, v6, v19
v_dot2_f32_bf16 v16, v51, v7, v16
v_dot2_f32_bf16 v17, v55, v7, v17
v_dot2_f32_bf16 v18, v59, v7, v18
v_dot2_f32_bf16 v19, v63, v7, v19
v_add_f32_dpp v16, v16, v16 row_ror:8 row_mask:0xf bank_mask:0x3
v_add_f32_dpp v16, v17, v17 row_ror:8 row_mask:0xf bank_mask:0xc
v_add_f32_dpp v18, v18, v18 row_ror:8 row_mask:0xf bank_mask:0x3
v_add_f32_dpp v18, v19, v19 row_ror:8 row_mask:0xf bank_mask:0xc
s_nop 0
v_add_f32_dpp v20, v16, v16 row_half_mirror row_mask:0xf bank_mask:0x5
v_add_f32_dpp v20, v18, v18 row_half_mirror row_mask:0xf bank_mask:0xa
s_waitcnt vmcnt(4)
buffer_load_dwordx4 v[96:99], v1, s[36:39], s60 offen offset:0 nt
buffer_load_dwordx4 v[100:103], v1, s[36:39], s60 offen offset:1024 nt
buffer_load_dwordx4 v[104:107], v1, s[36:39], s60 offen offset:2048 nt
buffer_load_dwordx4 v[108:111], v1, s[36:39], s60 offen offset:3072 nt
s_add_u32 s60, s60, 16384
s_and_b32 s60, s60, 524287
v_dot2_f32_bf16 v16, v64, v4, 0
v_dot2_f32_bf16 v17, v68, v4, 0
v_dot2_f32_bf16 v18, v72, v4, 0
v_dot2_f32_bf16 v19, v76, v4, 0
v_dot2_f32_bf16 v16, v65, v5, v16
v_dot2_f32_bf16 v17, v69, v5, v17
v_dot2_f32_bf16 v18, v73, v5, v18
v_dot2_f32_bf16 v19, v77, v5, v19
v_dot2_f32_bf16 v16, v66, v6, v16
v_dot2_f32_bf16 v17, v70, v6, v17
v_dot2_f32_bf16 v18, v74, v6, v18
v_dot2_f32_bf16 v19, v78, v6, v19
v_dot2_f32_bf16 v16, v67, v7, v16
v_dot2_f32_bf16 v17, v71, v7, v17
v_dot2_f32_bf16 v18, v75, v7, v18
v_dot2_f32_bf16 v19, v79, v7, v19
v_add_f32_dpp v16, v16, v16 row_ror:8 row_mask:0xf bank_mask:0x3
v_add_f32_dpp v16, v17, v17 row_ror:8 row_mask:0xf bank_mask:0xc
v_add_f32_dpp v18, v18, v18 row_ror:8 row_mask:0xf bank_mask:0x3
v_add_f32_dpp v18, v19, v19 row_ror:8 row_mask:0xf bank_mask:0xc
s_nop 0
v_add_f32_dpp v21, v16, v16 row_half_mirror row_mask:0xf bank_mask:0x5
v_add_f32_dpp v21, v18, v18 row_half_mirror row_mask:0xf bank_mask:0xa
s_waitcnt vmcnt(4)
s_cmp_eq_u32 s61, 7
s_cselect_b32 s36, s40, s36
s_cselect_b32 s37, s41, s37
buffer_load_dwordx4 v[48:51], v1, s[36:39], s60 offen offset:0 nt
buffer_load_dwordx4 v[52:55], v1, s[36:39], s60 offen offset:1024 nt
buffer_load_dwordx4 v[56:59], v1, s[36:39], s60 offen offset:2048 nt
buffer_load_dwordx4 v[60:63], v1, s[36:39], s60 offen offset:3072 nt
s_add_u32 s60, s60, 16384
s_and_b32 s60, s60, 524287
v_dot2_f32_bf16 v16, v80, v4, 0
v_dot2_f32_bf16 v17, v84, v4, 0
v_dot2_f32_bf16 v18, v88, v4, 0
v_dot2_f32_bf16 v19, v92, v4, 0
v_dot2_f32_bf16 v16, v81, v5, v16
v_dot2_f32_bf16 v17, v85, v5, v17
v_dot2_f32_bf16 v18, v89, v5, v18
v_dot2_f32_bf16 v19, v93, v5, v19
v_dot2_f32_bf16 v16, v82, v6, v16
v_dot2_f32_bf16 v17, v86, v6, v17
v_dot2_f32_bf16 v18, v90, v6, v18
v_dot2_f32_bf16 v19, v94, v6, v19
v_dot2_f32_bf16 v16, v83, v7, v16
v_dot2_f32_bf16 v17, v87, v7, v17
v_dot2_f32_bf16 v18, v91, v7, v18
v_dot2_f32_bf16 v19, v95, v7, v19
v_add_f32_dpp v16, v16, v16 row_ror:8 row_mask:0xf bank_mask:0x3
v_add_f32_dpp v16, v17, v17 row_ror:8 row_mask:0xf bank_mask:0xc
v_add_f32_dpp v18, v18, v18 row_ror:8 row_mask:0xf bank_mask:0x3
v_add_f32_dpp v18, v19, v19 row_ror:8 row_mask:0xf bank_mask:0xc
s_nop 0
v_add_f32_dpp v22, v16, v16 row_half_mirror row_mask:0xf bank_mask:0x5
v_add_f32_dpp v22, v18, v18 row_half_mirror row_mask:0xf bank_mask:0xa
s_waitcnt vmcnt(4)
buffer_load_dwordx4 v[64:67], v1, s[36:39], s60 offen offset:0 nt
buffer_load_dwordx4 v[68:71], v1, s[36:39], s60 offen offset:1024 nt
buffer_load_dwordx4 v[72:75], v1, s[36:39], s60 offen offset:2048 nt
buffer_load_dwordx4 v[76:79], v1, s[36:39], s60 offen offset:3072 nt
s_add_u32 s60, s60, 16384
s_and_b32 s60, s60, 524287
v_dot2_f32_bf16 v16, v96, v4, 0
v_dot2_f32_bf16 v17, v100, v4, 0
v_dot2_f32_bf16 v18, v104, v4, 0
v_dot2_f32_bf16 v19, v108, v4, 0
v_dot2_f32_bf16 v16, v97, v5, v16
v_dot2_f32_bf16 v17, v101, v5, v17
v_dot2_f32_bf16 v18, v105, v5, v18
v_dot2_f32_bf16 v19, v109, v5, v19
v_dot2_f32_bf16 v16, v98, v6, v16
v_dot2_f32_bf16 v17, v102, v6, v17
v_dot2_f32_bf16 v18, v106, v6, v18
v_dot2_f32_bf16 v19, v110, v6, v19
v_dot2_f32_bf16 v16, v99, v7, v16
v_dot2_f32_bf16 v17, v103, v7, v17
v_dot2_f32_bf16 v18, v107, v7, v18
v_dot2_f32_bf16 v19, v111, v7, v19
v_add_f32_dpp v16, v16, v16 row_ror:8 row_mask:0xf bank_mask:0x3
v_add_f32_dpp v16, v17, v17 row_ror:8 row_mask:0xf bank_mask:0xc
v_add_f32_dpp v18, v18, v18 row_ror:8 row_mask:0xf bank_mask:0x3
v_add_f32_dpp v18, v19, v19 row_ror:8 row_mask:0xf bank_mask:0xc
s_nop 0
v_add_f32_dpp v23, v16, v16 row_half_mirror row_mask:0xf bank_mask:0x5
v_add_f32_dpp v23, v18, v18 row_half_mirror row_mask:0xf bank_mask:0xa
v_add_f32_dpp v24, v20, v20 quad_perm:[2,3,0,1] row_mask:0xf bank_mask:0xf
v_add_f32_dpp v25, v21, v21 quad_perm:[2,3,0,1] row_mask:0xf bank_mask:0xf
v_add_f32_dpp v16, v22, v22 quad_perm:[2,3,0,1] row_mask:0xf bank_mask:0xf
v_add_f32_dpp v17, v23, v23 quad_perm:[2,3,0,1] row_mask:0xf bank_mask:0xf
v_cndmask_b32 v26, v24, v25, s[64:65]
v_cndmask_b32 v27, v16, v17, s[64:65]
s_nop 0
v_add_f32_dpp v24, v26, v26 quad_perm:[1,0,3,2] row_mask:0xf bank_mask:0xf
v_add_f32_dpp v25, v27, v27 quad_perm:[1,0,3,2] row_mask:0xf bank_mask:0xf
v_cndmask_b32 v24, v24, v25, s[66:67]
v_max_f32 v28, v28, v24
ds_write_b32 v29, v24 offset:0
v_add_u32 v29, 256, v29
s_add_u32 s61, s61, 1
s_cmp_lt_u32 s61, 8
s_cbranch_scc1 L_k
v_subrev_u32 v29, 2048, v29
s_nop 1
v_max_f32_dpp v28, v28, v28 row_ror:8 row_mask:0xf bank_mask:0xf
s_nop 1
v_max_f32_dpp v28, v28, v28 row_ror:4 row_mask:0xf bank_mask:0xf
s_nop 1
v_max_f32_dpp v28, v28, v28 row_ror:2 row_mask:0xf bank_mask:0xf
s_nop 1
v_max_f32_dpp v28, v28, v28 row_ror:1 row_mask:0xf bank_mask:0xf
ds_write_b32 v36, v28 offset:17920
s_waitcnt lgkmcnt(0)
s_barrier
ds_read_b32 v28, v37 offset:17920
ds_read2st64_b32 v[40:41], v29 offset0:0 offset1:1
ds_read2st64_b32 v[42:43], v29 offset0:2 offset1:3
ds_read2st64_b32 v[44:45], v29 offset0:4 offset1:5
ds_read2st64_b32 v[46:47], v29 offset0:6 offset1:7
s_waitcnt lgkmcnt(4)
s_nop 1
v_max_f32_dpp v28, v28, v28 row_ror:8 row_mask:0xf bank_mask:0xf
s_nop 1
v_max_f32_dpp v28, v28, v28 row_ror:4 row_mask:0xf bank_mask:0xf
s_nop 1
v_max_f32_dpp v28, v28, v28 row_ror:2 row_mask:0xf bank_mask:0xf
s_nop 1
v_max_f32_dpp v28, v28, v28 row_ror:1 row_mask:0xf bank_mask:0xf
v_mul_f32 v28, s63, v28
s_waitcnt lgkmcnt(0)
v_fma_f32 v40, v40, s63, -v28
v_fma_f32 v41, v41, s63, -v28
v_fma_f32 v42, v42, s63, -v28
v_fma_f32 v43, v43, s63, -v28
v_fma_f32 v44, v44, s63, -v28
v_fma_f32 v45, v45, s63, -v28
v_fma_f32 v46, v46, s63, -v28
v_fma_f32 v47, v47, s63, -v28
v_exp_f32 v40, v40
v_exp_f32 v41, v41
v_exp_f32 v42, v42
v_exp_f32 v43, v43
v_exp_f32 v44, v44
v_exp_f32 v45, v45
v_exp_f32 v46, v46
v_exp_f32 v47, v47
s_nop 0
v_add_f32 v24, v40, v41
v_add_f32 v24, v24, v42
v_add_f32 v24, v24, v43
v_add_f32 v24, v24, v44
v_add_f32 v24, v24, v45
v_add_f32 v24, v24, v46
v_add_f32 v24, v24, v47
v_cvt_pk_bf16_f32 v40, v40, 0
v_cvt_pk_bf16_f32 v41, v41, 0
v_cvt_pk_bf16_f32 v42, v42, 0
v_cvt_pk_bf16_f32 v43, v43, 0
v_cvt_pk_bf16_f32 v44, v44, 0
v_cvt_pk_bf16_f32 v45, v45, 0
v_cvt_pk_bf16_f32 v46, v46, 0
v_cvt_pk_bf16_f32 v47, v47, 0
ds_write2st64_b32 v29, v40, v41 offset0:0 offset1:1
ds_write2st64_b32 v29, v42, v43 offset0:2 offset1:3
ds_write2st64_b32 v29, v44, v45 offset0:4 offset1:5
ds_write2st64_b32 v29, v46, v47 offset0:6 offset1:7
s_nop 1
v_add_f32_dpp v24, v24, v24 row_ror:8 row_mask:0xf bank_mask:0xf
s_nop 1
v_add_f32_dpp v24, v24, v24 row_ror:4 row_mask:0xf bank_mask:0xf
s_nop 1
v_add_f32_dpp v24, v24, v24 row_ror:2 row_mask:0xf bank_mask:0xf
s_nop 1
v_add_f32_dpp v24, v24, v24 row_ror:1 row_mask:0xf bank_mask:0xf
ds_write_b32 v36, v24 offset:17984
s_mov_b32 s61, 0
s_waitcnt lgkmcnt(0)
s_barrier
.p2align 3
L_v:
ds_read_b32 v30, v29 offset:0
v_add_u32 v29, 256, v29
s_waitcnt vmcnt(4) lgkmcnt(0)
buffer_load_dwordx4 v[80:83], v1, s[36:39], s60 offen offset:0 nt
buffer_load_dwordx4 v[84:87], v1, s[36:39], s60 offen offset:1024 nt
buffer_load_dwordx4 v[88:91], v1, s[36:39], s60 offen offset:2048 nt
buffer_load_dwordx4 v[92:95], v1, s[36:39], s60 offen offset:3072 nt
s_add_u32 s60, s60, 16384
s_and_b32 s60, s60, 524287
v_lshlrev_b32 v32, 16, v30
s_nop 1
v_dot2c_f32_bf16_dpp v8, v30, v48 row_newbcast:0 row_mask:0xf bank_mask:0xf
v_dot2c_f32_bf16_dpp v9, v32, v48 row_newbcast:0 row_mask:0xf bank_mask:0xf
v_dot2c_f32_bf16_dpp v10, v30, v49 row_newbcast:0 row_mask:0xf bank_mask:0xf
v_dot2c_f32_bf16_dpp v11, v32, v49 row_newbcast:0 row_mask:0xf bank_mask:0xf
v_dot2c_f32_bf16_dpp v12, v30, v50 row_newbcast:0 row_mask:0xf bank_mask:0xf
v_dot2c_f32_bf16_dpp v13, v32, v50 row_newbcast:0 row_mask:0xf bank_mask:0xf
v_dot2c_f32_bf16_dpp v14, v30, v51 row_newbcast:0 row_mask:0xf bank_mask:0xf
v_dot2c_f32_bf16_dpp v15, v32, v51 row_newbcast:0 row_mask:0xf bank_mask:0xf
v_dot2c_f32_bf16_dpp v8, v30, v52 row_newbcast:8 row_mask:0xf bank_mask:0xf
v_dot2c_f32_bf16_dpp v9, v32, v52 row_newbcast:8 row_mask:0xf bank_mask:0xf
v_dot2c_f32_bf16_dpp v10, v30, v53 row_newbcast:8 row_mask:0xf bank_mask:0xf
v_dot2c_f32_bf16_dpp v11, v32, v53 row_newbcast:8 row_mask:0xf bank_mask:0xf
v_dot2c_f32_bf16_dpp v12, v30, v54 row_newbcast:8 row_mask:0xf bank_mask:0xf
v_dot2c_f32_bf16_dpp v13, v32, v54 row_newbcast:8 row_mask:0xf bank_mask:0xf
v_dot2c_f32_bf16_dpp v14, v30, v55 row_newbcast:8 row_mask:0xf bank_mask:0xf
v_dot2c_f32_bf16_dpp v15, v32, v55 row_newbcast:8 row_mask:0xf bank_mask:0xf
v_dot2c_f32_bf16_dpp v8, v30, v56 row_newbcast:4 row_mask:0xf bank_mask:0xf
v_dot2c_f32_bf16_dpp v9, v32, v56 row_newbcast:4 row_mask:0xf bank_mask:0xf
v_dot2c_f32_bf16_dpp v10, v30, v57 row_newbcast:4 row_mask:0xf bank_mask:0xf
v_dot2c_f32_bf16_dpp v11, v32, v57 row_newbcast:4 row_mask:0xf bank_mask:0xf
v_dot2c_f32_bf16_dpp v12, v30, v58 row_newbcast:4 row_mask:0xf bank_mask:0xf
v_dot2c_f32_bf16_dpp v13, v32, v58 row_newbcast:4 row_mask:0xf bank_mask:0xf
v_dot2c_f32_bf16_dpp v14, v30, v59 row_newbcast:4 row_mask:0xf bank_mask:0xf
v_dot2c_f32_bf16_dpp v15, v32, v59 row_newbcast:4 row_mask:0xf bank_mask:0xf
v_dot2c_f32_bf16_dpp v8, v30, v60 row_newbcast:12 row_mask:0xf bank_mask:0xf
v_dot2c_f32_bf16_dpp v9, v32, v60 row_newbcast:12 row_mask:0xf bank_mask:0xf
v_dot2c_f32_bf16_dpp v10, v30, v61 row_newbcast:12 row_mask:0xf bank_mask:0xf
v_dot2c_f32_bf16_dpp v11, v32, v61 row_newbcast:12 row_mask:0xf bank_mask:0xf
v_dot2c_f32_bf16_dpp v12, v30, v62 row_newbcast:12 row_mask:0xf bank_mask:0xf
v_dot2c_f32_bf16_dpp v13, v32, v62 row_newbcast:12 row_mask:0xf bank_mask:0xf
v_dot2c_f32_bf16_dpp v14, v30, v63 row_newbcast:12 row_mask:0xf bank_mask:0xf
v_dot2c_f32_bf16_dpp v15, v32, v63 row_newbcast:12 row_mask:0xf bank_mask:0xf
s_waitcnt vmcnt(4)
buffer_load_dwordx4 v[96:99], v1, s[36:39], s60 offen offset:0 nt
buffer_load_dwordx4 v[100:103], v1, s[36:39], s60 offen offset:1024 nt
buffer_load_dwordx4 v[104:107], v1, s[36:39], s60 offen offset:2048 nt
buffer_load_dwordx4 v[108:111], v1, s[36:39], s60 offen offset:3072 nt
s_add_u32 s60, s60, 16384
s_and_b32 s60, s60, 524287
v_dot2c_f32_bf16_dpp v8, v30, v64 row_newbcast:2 row_mask:0xf bank_mask:0xf
v_dot2c_f32_bf16_dpp v9, v32, v64 row_newbcast:2 row_mask:0xf bank_mask:0xf
v_dot2c_f32_bf16_dpp v10, v30, v65 row_newbcast:2 row_mask:0xf bank_mask:0xf
v_dot2c_f32_bf16_dpp v11, v32, v65 row_newbcast:2 row_mask:0xf bank_mask:0xf
v_dot2c_f32_bf16_dpp v12, v30, v66 row_newbcast:2 row_mask:0xf bank_mask:0xf
v_dot2c_f32_bf16_dpp v13, v32, v66 row_newbcast:2 row_mask:0xf bank_mask:0xf
v_dot2c_f32_bf16_dpp v14, v30, v67 row_newbcast:2 row_mask:0xf bank_mask:0xf
v_dot2c_f32_bf16_dpp v15, v32, v67 row_newbcast:2 row_mask:0xf bank_mask:0xf
v_dot2c_f32_bf16_dpp v8, v30, v68 row_newbcast:10 row_mask:0xf bank_mask:0xf
v_dot2c_f32_bf16_dpp v9, v32, v68 row_newbcast:10 row_mask:0xf bank_mask:0xf
v_dot2c_f32_bf16_dpp v10, v30, v69 row_newbcast:10 row_mask:0xf bank_mask:0xf
v_dot2c_f32_bf16_dpp v11, v32, v69 row_newbcast:10 row_mask:0xf bank_mask:0xf
v_dot2c_f32_bf16_dpp v12, v30, v70 row_newbcast:10 row_mask:0xf bank_mask:0xf
v_dot2c_f32_bf16_dpp v13, v32, v70 row_newbcast:10 row_mask:0xf bank_mask:0xf
v_dot2c_f32_bf16_dpp v14, v30, v71 row_newbcast:10 row_mask:0xf bank_mask:0xf
v_dot2c_f32_bf16_dpp v15, v32, v71 row_newbcast:10 row_mask:0xf bank_mask:0xf
v_dot2c_f32_bf16_dpp v8, v30, v72 row_newbcast:6 row_mask:0xf bank_mask:0xf
v_dot2c_f32_bf16_dpp v9, v32, v72 row_newbcast:6 row_mask:0xf bank_mask:0xf
v_dot2c_f32_bf16_dpp v10, v30, v73 row_newbcast:6 row_mask:0xf bank_mask:0xf
v_dot2c_f32_bf16_dpp v11, v32, v73 row_newbcast:6 row_mask:0xf bank_mask:0xf
v_dot2c_f32_bf16_dpp v12, v30, v74 row_newbcast:6 row_mask:0xf bank_mask:0xf
v_dot2c_f32_bf16_dpp v13, v32, v74 row_newbcast:6 row_mask:0xf bank_mask:0xf
v_dot2c_f32_bf16_dpp v14, v30, v75 row_newbcast:6 row_mask:0xf bank_mask:0xf
v_dot2c_f32_bf16_dpp v15, v32, v75 row_newbcast:6 row_mask:0xf bank_mask:0xf
v_dot2c_f32_bf16_dpp v8, v30, v76 row_newbcast:14 row_mask:0xf bank_mask:0xf
v_dot2c_f32_bf16_dpp v9, v32, v76 row_newbcast:14 row_mask:0xf bank_mask:0xf
v_dot2c_f32_bf16_dpp v10, v30, v77 row_newbcast:14 row_mask:0xf bank_mask:0xf
v_dot2c_f32_bf16_dpp v11, v32, v77 row_newbcast:14 row_mask:0xf bank_mask:0xf
v_dot2c_f32_bf16_dpp v12, v30, v78 row_newbcast:14 row_mask:0xf bank_mask:0xf
v_dot2c_f32_bf16_dpp v13, v32, v78 row_newbcast:14 row_mask:0xf bank_mask:0xf
v_dot2c_f32_bf16_dpp v14, v30, v79 row_newbcast:14 row_mask:0xf bank_mask:0xf
v_dot2c_f32_bf16_dpp v15, v32, v79 row_newbcast:14 row_mask:0xf bank_mask:0xf
s_waitcnt vmcnt(4)
s_cmp_eq_u32 s61, 7
s_cselect_b32 s36, s42, s36
s_cselect_b32 s37, s43, s37
s_cselect_b32 s38, s46, s38
buffer_load_dwordx4 v[48:51], v1, s[36:39], s60 offen offset:0 nt
buffer_load_dwordx4 v[52:55], v1, s[36:39], s60 offen offset:1024 nt
buffer_load_dwordx4 v[56:59], v1, s[36:39], s60 offen offset:2048 nt
buffer_load_dwordx4 v[60:63], v1, s[36:39], s60 offen offset:3072 nt
s_add_u32 s60, s60, 16384
s_and_b32 s60, s60, 524287
v_dot2c_f32_bf16_dpp v8, v30, v80 row_newbcast:1 row_mask:0xf bank_mask:0xf
v_dot2c_f32_bf16_dpp v9, v32, v80 row_newbcast:1 row_mask:0xf bank_mask:0xf
v_dot2c_f32_bf16_dpp v10, v30, v81 row_newbcast:1 row_mask:0xf bank_mask:0xf
v_dot2c_f32_bf16_dpp v11, v32, v81 row_newbcast:1 row_mask:0xf bank_mask:0xf
v_dot2c_f32_bf16_dpp v12, v30, v82 row_newbcast:1 row_mask:0xf bank_mask:0xf
v_dot2c_f32_bf16_dpp v13, v32, v82 row_newbcast:1 row_mask:0xf bank_mask:0xf
v_dot2c_f32_bf16_dpp v14, v30, v83 row_newbcast:1 row_mask:0xf bank_mask:0xf
v_dot2c_f32_bf16_dpp v15, v32, v83 row_newbcast:1 row_mask:0xf bank_mask:0xf
v_dot2c_f32_bf16_dpp v8, v30, v84 row_newbcast:9 row_mask:0xf bank_mask:0xf
v_dot2c_f32_bf16_dpp v9, v32, v84 row_newbcast:9 row_mask:0xf bank_mask:0xf
v_dot2c_f32_bf16_dpp v10, v30, v85 row_newbcast:9 row_mask:0xf bank_mask:0xf
v_dot2c_f32_bf16_dpp v11, v32, v85 row_newbcast:9 row_mask:0xf bank_mask:0xf
v_dot2c_f32_bf16_dpp v12, v30, v86 row_newbcast:9 row_mask:0xf bank_mask:0xf
v_dot2c_f32_bf16_dpp v13, v32, v86 row_newbcast:9 row_mask:0xf bank_mask:0xf
v_dot2c_f32_bf16_dpp v14, v30, v87 row_newbcast:9 row_mask:0xf bank_mask:0xf
v_dot2c_f32_bf16_dpp v15, v32, v87 row_newbcast:9 row_mask:0xf bank_mask:0xf
v_dot2c_f32_bf16_dpp v8, v30, v88 row_newbcast:5 row_mask:0xf bank_mask:0xf
v_dot2c_f32_bf16_dpp v9, v32, v88 row_newbcast:5 row_mask:0xf bank_mask:0xf
v_dot2c_f32_bf16_dpp v10, v30, v89 row_newbcast:5 row_mask:0xf bank_mask:0xf
v_dot2c_f32_bf16_dpp v11, v32, v89 row_newbcast:5 row_mask:0xf bank_mask:0xf
v_dot2c_f32_bf16_dpp v12, v30, v90 row_newbcast:5 row_mask:0xf bank_mask:0xf
v_dot2c_f32_bf16_dpp v13, v32, v90 row_newbcast:5 row_mask:0xf bank_mask:0xf
v_dot2c_f32_bf16_dpp v14, v30, v91 row_newbcast:5 row_mask:0xf bank_mask:0xf
v_dot2c_f32_bf16_dpp v15, v32, v91 row_newbcast:5 row_mask:0xf bank_mask:0xf
v_dot2c_f32_bf16_dpp v8, v30, v92 row_newbcast:13 row_mask:0xf bank_mask:0xf
v_dot2c_f32_bf16_dpp v9, v32, v92 row_newbcast:13 row_mask:0xf bank_mask:0xf
v_dot2c_f32_bf16_dpp v10, v30, v93 row_newbcast:13 row_mask:0xf bank_mask:0xf
v_dot2c_f32_bf16_dpp v11, v32, v93 row_newbcast:13 row_mask:0xf bank_mask:0xf
v_dot2c_f32_bf16_dpp v12, v30, v94 row_newbcast:13 row_mask:0xf bank_mask:0xf
v_dot2c_f32_bf16_dpp v13, v32, v94 row_newbcast:13 row_mask:0xf bank_mask:0xf
v_dot2c_f32_bf16_dpp v14, v30, v95 row_newbcast:13 row_mask:0xf bank_mask:0xf
v_dot2c_f32_bf16_dpp v15, v32, v95 row_newbcast:13 row_mask:0xf bank_mask:0xf
s_waitcnt vmcnt(4)
buffer_load_dwordx4 v[64:67], v1, s[36:39], s60 offen offset:0 nt
buffer_load_dwordx4 v[68:71], v1, s[36:39], s60 offen offset:1024 nt
buffer_load_dwordx4 v[72:75], v1, s[36:39], s60 offen offset:2048 nt
buffer_load_dwordx4 v[76:79], v1, s[36:39], s60 offen offset:3072 nt
s_add_u32 s60, s60, 16384
s_and_b32 s60, s60, 524287
v_dot2c_f32_bf16_dpp v8, v30, v96 row_newbcast:3 row_mask:0xf bank_mask:0xf
v_dot2c_f32_bf16_dpp v9, v32, v96 row_newbcast:3 row_mask:0xf bank_mask:0xf
v_dot2c_f32_bf16_dpp v10, v30, v97 row_newbcast:3 row_mask:0xf bank_mask:0xf
v_dot2c_f32_bf16_dpp v11, v32, v97 row_newbcast:3 row_mask:0xf bank_mask:0xf
v_dot2c_f32_bf16_dpp v12, v30, v98 row_newbcast:3 row_mask:0xf bank_mask:0xf
v_dot2c_f32_bf16_dpp v13, v32, v98 row_newbcast:3 row_mask:0xf bank_mask:0xf
v_dot2c_f32_bf16_dpp v14, v30, v99 row_newbcast:3 row_mask:0xf bank_mask:0xf
v_dot2c_f32_bf16_dpp v15, v32, v99 row_newbcast:3 row_mask:0xf bank_mask:0xf
v_dot2c_f32_bf16_dpp v8, v30, v100 row_newbcast:11 row_mask:0xf bank_mask:0xf
v_dot2c_f32_bf16_dpp v9, v32, v100 row_newbcast:11 row_mask:0xf bank_mask:0xf
v_dot2c_f32_bf16_dpp v10, v30, v101 row_newbcast:11 row_mask:0xf bank_mask:0xf
v_dot2c_f32_bf16_dpp v11, v32, v101 row_newbcast:11 row_mask:0xf bank_mask:0xf
v_dot2c_f32_bf16_dpp v12, v30, v102 row_newbcast:11 row_mask:0xf bank_mask:0xf
v_dot2c_f32_bf16_dpp v13, v32, v102 row_newbcast:11 row_mask:0xf bank_mask:0xf
v_dot2c_f32_bf16_dpp v14, v30, v103 row_newbcast:11 row_mask:0xf bank_mask:0xf
v_dot2c_f32_bf16_dpp v15, v32, v103 row_newbcast:11 row_mask:0xf bank_mask:0xf
v_dot2c_f32_bf16_dpp v8, v30, v104 row_newbcast:7 row_mask:0xf bank_mask:0xf
v_dot2c_f32_bf16_dpp v9, v32, v104 row_newbcast:7 row_mask:0xf bank_mask:0xf
v_dot2c_f32_bf16_dpp v10, v30, v105 row_newbcast:7 row_mask:0xf bank_mask:0xf
v_dot2c_f32_bf16_dpp v11, v32, v105 row_newbcast:7 row_mask:0xf bank_mask:0xf
v_dot2c_f32_bf16_dpp v12, v30, v106 row_newbcast:7 row_mask:0xf bank_mask:0xf
v_dot2c_f32_bf16_dpp v13, v32, v106 row_newbcast:7 row_mask:0xf bank_mask:0xf
v_dot2c_f32_bf16_dpp v14, v30, v107 row_newbcast:7 row_mask:0xf bank_mask:0xf
v_dot2c_f32_bf16_dpp v15, v32, v107 row_newbcast:7 row_mask:0xf bank_mask:0xf
v_dot2c_f32_bf16_dpp v8, v30, v108 row_newbcast:15 row_mask:0xf bank_mask:0xf
v_dot2c_f32_bf16_dpp v9, v32, v108 row_newbcast:15 row_mask:0xf bank_mask:0xf
v_dot2c_f32_bf16_dpp v10, v30, v109 row_newbcast:15 row_mask:0xf bank_mask:0xf
v_dot2c_f32_bf16_dpp v11, v32, v109 row_newbcast:15 row_mask:0xf bank_mask:0xf
v_dot2c_f32_bf16_dpp v12, v30, v110 row_newbcast:15 row_mask:0xf bank_mask:0xf
v_dot2c_f32_bf16_dpp v13, v32, v110 row_newbcast:15 row_mask:0xf bank_mask:0xf
v_dot2c_f32_bf16_dpp v14, v30, v111 row_newbcast:15 row_mask:0xf bank_mask:0xf
v_dot2c_f32_bf16_dpp v15, v32, v111 row_newbcast:15 row_mask:0xf bank_mask:0xf
s_add_u32 s61, s61, 1
s_cmp_lt_u32 s61, 8
s_cbranch_scc1 L_v
s_nop 2
ds_write_b128 v34, v[8:11] offset:0
ds_write_b128 v34, v[12:15] offset:1088
s_waitcnt lgkmcnt(0)
s_barrier
s_cmp_eq_u32 s46, 0
s_cbranch_scc1 L_sdone
ds_read_b128 v[4:7], v38 offset:17664
v_subrev_u32 v29, 2048, v29
s_mov_b32 s40, s44
s_mov_b32 s41, s45
s_mov_b32 s46, 0
s_branch L_set
L_sdone:
L_end:
s_endpgm
.globl mha_final_kernel
.p2align 8
.type mha_final_kernel,@function
mha_final_kernel:
s_load_dwordx2 s[4:5], s[0:1], 80
s_load_dwordx2 s[8:9], s[0:1], 96
s_cmp_ge_u32 s2, 128
s_cbranch_scc1 L_end2
s_bfe_u32 s12, s2, 0x20001
s_and_b32 s13, s2, 1
s_lshl_b32 s13, s13, 4
s_lshr_b32 s14, s2, 3
s_add_u32 s13, s13, s14
v_lshrrev_b32 v1, 2, v0
v_and_b32 v2, 3, v0
v_lshlrev_b32 v3, 14, v1
v_lshlrev_b32 v4, 4, v2
v_add_u32 v3, v3, v4
v_add_u32 v5, 4096, v3
v_add_u32 v6, 0x2000, v3
v_add_u32 v7, 0x3000, v3
v_lshlrev_b32 v4, 6, v1
s_lshl_b32 s14, s12, 18
s_lshl_b32 s15, s13, 6
s_add_u32 s14, s14, s15
s_lshl_b32 s15, s12, 10
s_add_u32 s15, s15, 1048576
s_mov_b32 s10, 1052672
s_mov_b32 s11, 0x20000
s_mov_b32 s6, 4096
s_mov_b32 s7, 0x20000
s_waitcnt lgkmcnt(0)
buffer_load_dwordx4 v[8:11], v4, s[8:11], s15 offen offset:0
buffer_load_dwordx4 v[12:15], v4, s[8:11], s15 offen offset:16
buffer_load_dwordx4 v[16:19], v4, s[8:11], s15 offen offset:32
buffer_load_dwordx4 v[20:23], v4, s[8:11], s15 offen offset:48
buffer_load_dwordx4 v[24:27], v3, s[8:11], s14 offen offset:0
buffer_load_dwordx4 v[28:31], v3, s[8:11], s14 offen offset:2048
buffer_load_dwordx4 v[32:35], v5, s[8:11], s14 offen offset:0
buffer_load_dwordx4 v[36:39], v5, s[8:11], s14 offen offset:2048
buffer_load_dwordx4 v[40:43], v6, s[8:11], s14 offen offset:0
buffer_load_dwordx4 v[44:47], v6, s[8:11], s14 offen offset:2048
buffer_load_dwordx4 v[48:51], v7, s[8:11], s14 offen offset:0
buffer_load_dwordx4 v[52:55], v7, s[8:11], s14 offen offset:2048
s_and_b32 s16, s12, 1
s_lshl_b32 s16, s16, 11
s_lshr_b32 s17, s12, 1
s_lshl_b32 s17, s17, 10
s_add_u32 s16, s16, s17
s_lshl_b32 s17, s13, 5
s_add_u32 s16, s16, s17
v_lshlrev_b32 v1, 3, v2
s_waitcnt vmcnt(8)
v_max3_f32 v56, v8, v10, v12
v_max_f32 v56, v56, v14
v_sub_f32 v8, v8, v56
v_sub_f32 v10, v10, v56
v_sub_f32 v12, v12, v56
v_sub_f32 v14, v14, v56
v_exp_f32 v8, v8
v_exp_f32 v10, v10
v_exp_f32 v12, v12
v_exp_f32 v14, v14
s_nop 0
v_mul_f32 v57, v8, v9
v_fmac_f32 v57, v10, v11
v_fmac_f32 v57, v12, v13
v_fmac_f32 v57, v14, v15
v_rcp_f32 v57, v57
s_nop 0
v_mul_f32 v8, v8, v57
v_mul_f32 v10, v10, v57
v_mul_f32 v12, v12, v57
v_mul_f32 v14, v14, v57
v_max3_f32 v56, v16, v18, v20
v_max_f32 v56, v56, v22
v_sub_f32 v16, v16, v56
v_sub_f32 v18, v18, v56
v_sub_f32 v20, v20, v56
v_sub_f32 v22, v22, v56
v_exp_f32 v16, v16
v_exp_f32 v18, v18
v_exp_f32 v20, v20
v_exp_f32 v22, v22
s_nop 0
v_mul_f32 v57, v16, v17
v_fmac_f32 v57, v18, v19
v_fmac_f32 v57, v20, v21
v_fmac_f32 v57, v22, v23
v_rcp_f32 v57, v57
s_nop 0
v_mul_f32 v16, v16, v57
v_mul_f32 v18, v18, v57
v_mul_f32 v20, v20, v57
v_mul_f32 v22, v22, v57
s_waitcnt vmcnt(7)
v_mul_f32 v24, v8, v24
v_mul_f32 v25, v8, v25
v_mul_f32 v26, v8, v26
v_mul_f32 v27, v8, v27
s_waitcnt vmcnt(6)
v_fmac_f32 v24, v10, v28
v_fmac_f32 v25, v10, v29
v_fmac_f32 v26, v10, v30
v_fmac_f32 v27, v10, v31
s_waitcnt vmcnt(5)
v_fmac_f32 v24, v12, v32
v_fmac_f32 v25, v12, v33
v_fmac_f32 v26, v12, v34
v_fmac_f32 v27, v12, v35
s_waitcnt vmcnt(4)
v_fmac_f32 v24, v14, v36
v_fmac_f32 v25, v14, v37
v_fmac_f32 v26, v14, v38
v_fmac_f32 v27, v14, v39
s_waitcnt vmcnt(3)
v_fmac_f32 v24, v16, v40
v_fmac_f32 v25, v16, v41
v_fmac_f32 v26, v16, v42
v_fmac_f32 v27, v16, v43
s_waitcnt vmcnt(2)
v_fmac_f32 v24, v18, v44
v_fmac_f32 v25, v18, v45
v_fmac_f32 v26, v18, v46
v_fmac_f32 v27, v18, v47
s_waitcnt vmcnt(1)
v_fmac_f32 v24, v20, v48
v_fmac_f32 v25, v20, v49
v_fmac_f32 v26, v20, v50
v_fmac_f32 v27, v20, v51
s_waitcnt vmcnt(0)
v_fmac_f32 v24, v22, v52
v_fmac_f32 v25, v22, v53
v_fmac_f32 v26, v22, v54
v_fmac_f32 v27, v22, v55
s_nop 1
v_add_f32_dpp v24, v24, v24 row_ror:4 row_mask:0xf bank_mask:0xf
v_add_f32_dpp v25, v25, v25 row_ror:4 row_mask:0xf bank_mask:0xf
v_add_f32_dpp v26, v26, v26 row_ror:4 row_mask:0xf bank_mask:0xf
v_add_f32_dpp v27, v27, v27 row_ror:4 row_mask:0xf bank_mask:0xf
s_nop 1
v_add_f32_dpp v24, v24, v24 row_ror:8 row_mask:0xf bank_mask:0xf
v_add_f32_dpp v25, v25, v25 row_ror:8 row_mask:0xf bank_mask:0xf
v_add_f32_dpp v26, v26, v26 row_ror:8 row_mask:0xf bank_mask:0xf
v_add_f32_dpp v27, v27, v27 row_ror:8 row_mask:0xf bank_mask:0xf
v_mov_b32 v28, v24
v_mov_b32 v29, v25
v_mov_b32 v30, v26
v_mov_b32 v31, v27
s_nop 1
v_permlane16_swap_b32 v24, v28
v_permlane16_swap_b32 v25, v29
v_permlane16_swap_b32 v26, v30
v_permlane16_swap_b32 v27, v31
s_nop 1
v_add_f32 v24, v24, v28
v_add_f32 v25, v25, v29
v_add_f32 v26, v26, v30
v_add_f32 v27, v27, v31
v_mov_b32 v28, v24
v_mov_b32 v29, v25
v_mov_b32 v30, v26
v_mov_b32 v31, v27
s_nop 1
v_permlane32_swap_b32 v24, v28
v_permlane32_swap_b32 v25, v29
v_permlane32_swap_b32 v26, v30
v_permlane32_swap_b32 v27, v31
s_nop 1
v_add_f32 v24, v24, v28
v_add_f32 v25, v25, v29
v_add_f32 v26, v26, v30
v_add_f32 v27, v27, v31
v_cvt_pk_bf16_f32 v24, v24, v25
v_cvt_pk_bf16_f32 v25, v26, v27
s_mov_b64 exec, 15
buffer_store_dwordx2 v[24:25], v1, s[4:7], s16 offen
L_end2:
s_endpgm
.section .rodata,"a"
.p2align 6
.amdhsa_kernel concat_heads__mha_block_cached__mha_block_cached__decode_kernel
  .amdhsa_next_free_vgpr 180
  .amdhsa_next_free_sgpr 80
  .amdhsa_accum_offset 180
  .amdhsa_group_segment_fixed_size 0
  .amdhsa_kernarg_size 104
  .amdhsa_user_sgpr_count 2
  .amdhsa_user_sgpr_kernarg_segment_ptr 1
  .amdhsa_system_sgpr_workgroup_id_x 1
.end_amdhsa_kernel
.section .rodata,"a"
.p2align 6
.amdhsa_kernel mha_final_kernel
  .amdhsa_next_free_vgpr 60
  .amdhsa_next_free_sgpr 24
  .amdhsa_accum_offset 60
  .amdhsa_group_segment_fixed_size 0
  .amdhsa_kernarg_size 104
  .amdhsa_user_sgpr_count 2
  .amdhsa_user_sgpr_kernarg_segment_ptr 1
  .amdhsa_system_sgpr_workgroup_id_x 1
.end_amdhsa_kernel
```
